```python
import torch

def _softmax(x, axis=-1):
    return torch.softmax(x, dim=axis)
def _gelu(x):
    return torch.nn.functional.gelu(x, approximate="tanh")
def _silu(x):
    return torch.nn.functional.silu(x)
def _sigmoid(x):
    return torch.sigmoid(x)
def _layernorm(x, axis=-1, eps=1e-5):
    m = x.mean(dim=axis, keepdim=True)
    v = x.var(dim=axis, keepdim=True, unbiased=False)
    return (x - m) / torch.sqrt(v + eps)
def _scatter_add(tgt, idx, src, axis=0):
    return tgt.clone().index_add_(axis, idx, src)
def _segment_sum(src, seg, n):
    out = torch.zeros((n,) + src.shape[1:], dtype=src.dtype)
    return out.index_add_(0, seg, src)
def _pad(x, pw):
    flat = tuple(v for pair in reversed(pw) for v in pair)
    return torch.nn.functional.pad(x, flat)

kernel_name = 'standalone__convnext_block__vision'

def setup_inputs():

    _w = (lambda a: (lambda t: t.to(torch.bfloat16) if t.is_floating_point() else t)(torch.as_tensor(a)))
    H = W = 224
    C = 96
    return {
        "x": _w((lambda *s: torch.randn(*s, dtype=torch.bfloat16) * 0.05)(1, H, W, C)),
        "dw": _w((lambda *s: torch.randn(*s, dtype=torch.bfloat16) * 0.05)(7, 7, C)),
        "w1": _w((lambda *s: torch.randn(*s, dtype=torch.bfloat16) * 0.05)(C, 4 * C)),
        "w2": _w((lambda *s: torch.randn(*s, dtype=torch.bfloat16) * 0.05)(4 * C, C)),
    }

def reference(x, dw, w1, w2):
    B, H, W, C = x.shape
    pad = 3
    xp = _pad(x, ((0,0),(pad,pad),(pad,pad),(0,0)))
    out = torch.zeros_like(x)
    for i in range(7):
        for j in range(7):
            out = out + xp[:, i:i+H, j:j+W, :] * dw[i, j][None, None, None, :]
    h = _layernorm(out, axis=-1)
    return x + _gelu(h @ w1) @ w2
```

```asm
; @launch grid=(256,1,1) block=(512,1,1) lds=163840
.amdgcn_target "amdgcn-amd-amdhsa--gfx950"
.text
.globl standalone__convnext_block__vision_kernel
.p2align 8
.type standalone__convnext_block__vision_kernel,@function
standalone__convnext_block__vision_kernel:
    s_load_dwordx8 s[4:11], s[0:1], 0
    s_load_dwordx2 s[12:13], s[0:1], 32
    s_cmp_ge_u32 s2, 256
    s_cbranch_scc1 L_end
    v_lshrrev_b32 v2, 6, v0
    v_and_b32 v1, 63, v0
    v_readfirstlane_b32 s40, v2
    v_lshlrev_b32 v9, 4, v1
    s_getpc_b64 s[76:77]
L_pc:
    s_lshr_b32 s47, s2, 3
    s_lshl_b32 s47, s47, 3
    s_add_u32 s47, s47, s40
    s_lshl_b32 s47, s47, 10
    v_add_u32 v240, s47, v9
    v_min_u32 v240, L_cend-L_pc-16, v240
    v_mov_b32 v243, s77
    v_add_co_u32 v242, vcc, s76, v240
    s_nop 1
    v_addc_co_u32 v243, vcc, 0, v243, vcc
    global_load_dwordx4 v[244:247], v[242:243], off
    s_and_b32 s41, s2, 7
    s_lshl_b32 s41, s41, 5
    s_lshr_b32 s42, s2, 3
    s_add_u32 s41, s41, s42
    s_lshr_b32 s42, s41, 4
    s_and_b32 s43, s41, 15
    s_mul_i32 s42, s42, 14
    s_mul_i32 s43, s43, 14
    s_movk_i32 s45, 192
    s_mov_b32 s46, 0x40000000
    s_movk_i32 s49, 224
    v_mul_u32_u24 v5, 43, v1
    v_lshrrev_b32 v5, 9, v5
    v_mul_u32_u24 v6, 12, v5
    v_sub_u32 v6, v1, v6
    s_and_b32 s47, s40, 1
    s_mul_i32 s48, s47, 10
    s_add_u32 s48, s48, s43
    s_sub_u32 s48, s48, 3
    v_lshl_add_u32 v7, v5, 1, s48
    v_lshlrev_b32 v8, 4, v6
    v_mad_i32_i24 v8, v7, s45, v8
    v_cmp_gt_u32 vcc, s49, v7
    v_add_u32 v7, 1, v7
    v_cmp_gt_u32_e64 s[50:51], s49, v7
    v_mov_b32 v3, s46
    s_and_b32 vcc_hi, vcc_hi, 0x0fffffff
    s_and_b32 s51, s51, 0x0fffffff
    s_and_b32 s58, s40, 3
    s_mul_i32 s52, s58, 2688
    s_add_u32 m0, s52, 100992
    v_cndmask_b32 v10, v3, v8, vcc
    v_add_u32 v8, 0xc0, v8
    v_cndmask_b32_e64 v11, v3, v8, s[50:51]
    s_lshr_b32 s53, s40, 1
    s_add_u32 s41, s53, 2
    s_cmp_lt_u32 s40, 4
    s_cselect_b32 s53, s53, s41
    s_lshl_b32 s59, s53, 1
    s_add_u32 s59, s59, s42
    s_sub_u32 s59, s59, 3
    s_waitcnt lgkmcnt(0)
    s_mov_b32 s64, s4
    s_mov_b32 s65, s5
    s_mov_b32 s66, 0
    s_mov_b32 s67, 0x00020000
    s_cmp_ge_u32 s40, 4
    s_cbranch_scc1 L_dw
    s_add_u32 s47, s59, 0
    s_cmp_lt_u32 s47, 224
    s_cselect_b32 s66, 9633792, 0
    s_mul_i32 s48, s47, 43008
    buffer_load_dwordx4 v[128:131], v10, s[64:67], s48 offen nt
    buffer_load_dwordx4 v[132:135], v11, s[64:67], s48 offen nt
    s_add_u32 s47, s59, 1
    s_cmp_lt_u32 s47, 224
    s_cselect_b32 s66, 9633792, 0
    s_mul_i32 s48, s47, 43008
    buffer_load_dwordx4 v[136:139], v10, s[64:67], s48 offen nt
    buffer_load_dwordx4 v[140:143], v11, s[64:67], s48 offen nt
    s_add_u32 s47, s59, 4
    s_cmp_lt_u32 s47, 224
    s_cselect_b32 s66, 9633792, 0
    s_mul_i32 s48, s47, 43008
    buffer_load_dwordx4 v[144:147], v10, s[64:67], s48 offen nt
    buffer_load_dwordx4 v[148:151], v11, s[64:67], s48 offen nt
    s_add_u32 s47, s59, 5
    s_cmp_lt_u32 s47, 224
    s_cselect_b32 s66, 9633792, 0
    s_mul_i32 s48, s47, 43008
    buffer_load_dwordx4 v[152:155], v10, s[64:67], s48 offen nt
    buffer_load_dwordx4 v[156:159], v11, s[64:67], s48 offen nt
    s_branch L_su
L_dw:
    s_setprio 3
    s_mov_b32 s20, s6
    s_mov_b32 s21, s7
    s_mov_b32 s22, 9408
    s_mov_b32 s23, 0x00020000
    buffer_load_dwordx4 v9, s[20:23], s52 offen lds
    buffer_load_dwordx4 v9, s[20:23], s52 offen offset:1024 lds
    s_mov_b32 exec_hi, 0xff
    buffer_load_dwordx4 v9, s[20:23], s52 offen offset:2048 lds
    s_mov_b64 exec, -1
L_su:
    s_cmp_lt_u32 s40, 4
    s_cselect_b32 s41, s40, s41
    s_cselect_b32 s44, 0, 1
    s_and_b32 s44, s44, s40
    s_mov_b32 s56, 0x05040100
    s_mov_b32 s57, 0x07060302
    v_and_b32 v0, 2, v1
    s_add_u32 s47, s52, 100992
    v_lshl_add_u32 v13, v1, 2, s47
    v_mul_u32_u24 v8, 672, v0
    v_add_u32 v13, v13, v8
    s_lshl_b32 s47, s58, 5
    s_add_u32 s47, s47, 74896
    v_mul_u32_u24 v14, 544, v1
    v_lshl_add_u32 v14, v0, 3, v14
    v_add_u32 v14, s47, v14
    v_lshrrev_b32 v7, 2, v1
    v_lshrrev_b32 v8, 3, v1
    v_lshrrev_b32 v2, 4, v1
    v_xor_b32 v8, v8, v2
    v_and_b32 v8, 1, v8
    v_xor_b32 v19, v7, v8
    s_lshl_b32 s47, s41, 4
    v_add_u32 v7, s47, v19
    v_mul_u32_u24 v17, 272, v7
    v_and_b32 v8, 1, v1
    v_lshlrev_b32 v8, 7, v8
    v_lshlrev_b32 v0, 3, v0
    v_sub_u32 v8, v8, v0
    v_add_u32 v8, 74896, v8
    v_add_u32 v17, v17, v8
    v_and_b32 v2, 3, v1
    v_bfe_u32 v3, v1, 2, 2
    v_lshrrev_b32 v4, 4, v1
    s_and_b32 s47, s40, 1
    s_mul_i32 s47, s47, 40
    s_mul_i32 s48, s53, 9408
    s_add_u32 s47, s47, s48
    s_add_u32 s47, s47, 18432
    v_mul_u32_u24 v12, 784, v6
    v_lshl_add_u32 v12, v5, 3, v12
    v_add_u32 v12, s47, v12
    s_and_b32 s47, s40, 1
    s_xor_b32 s47, s47, 1
    s_mul_i32 s47, s47, 40
    s_mov_b32 exec_lo, 0
    s_mov_b32 exec_hi, 0xf0000000
    v_add_u32 v12, s47, v12
    s_mov_b64 exec, -1
    v_mul_u32_u24 v7, 448, v7
    s_lshl_b32 s47, s44, 3
    s_add_u32 s47, s47, 115392
    v_lshl_add_u32 v15, v2, 4, v7
    v_add_u32 v15, s47, v15
    s_lshl_b32 s47, s44, 6
    s_add_u32 s47, s47, 115448
    v_lshl_add_u32 v16, v2, 7, v7
    v_add_u32 v16, s47, v16
    s_cmp_eq_u32 s44, 0
    s_cselect_b32 s68, -1, 0x77777777
    s_mov_b32 s69, s68
    s_mov_b32 s70, 0x77777777
    s_mov_b32 s71, s70
    v_lshrrev_b32 v0, 5, v1
    v_mul_u32_u24 v0, 784, v0
    v_and_b32 v7, 7, v19
    v_mul_u32_u24 v7, 96, v7
    v_lshl_add_u32 v7, v2, 4, v7
    s_mul_i32 s47, s41, 1568
    s_lshl_b32 s48, s44, 3
    s_add_u32 s47, s47, s48
    s_add_u32 s47, s47, 18432
    v_add3_u32 v18, v0, v7, s47
    v_add_u32 v19, 47040, v18
    v_add_u32 v225, 158400, v9
    s_mov_b32 s16, s4
    s_mov_b32 s17, s5
    s_mov_b32 s18, 9633792
    s_mov_b32 s19, 0x00020000
    s_mov_b32 s24, s8
    s_mov_b32 s25, s9
    s_mov_b32 s26, 73728
    s_mov_b32 s27, 0x00020000
    s_mov_b32 s28, s10
    s_mov_b32 s29, s11
    s_mov_b32 s30, 73728
    s_mov_b32 s31, 0x00020000
    s_mov_b32 s32, s12
    s_mov_b32 s33, s13
    s_mov_b32 s34, 9633792
    s_mov_b32 s35, 0x00020000
    v_lshrrev_b32 v0, 5, v1
    v_lshl_add_u32 v7, v0, 2, v3
    v_and_b32 v8, 1, v4
    v_lshlrev_b32 v5, 5, v8
    v_lshl_add_u32 v5, v2, 3, v5
    s_mul_i32 s50, s44, 6144
    v_lshl_add_u32 v6, v7, 6, s50
    v_add_u32 v228, v6, v5
    v_mul_u32_u24 v7, 448, v7
    s_lshl_b32 s50, s41, 6
    s_add_u32 s50, s50, 115392
    v_add3_u32 v231, v7, v5, s50
    v_and_b32 v5, 1, v2
    v_lshlrev_b32 v5, 5, v5
    v_lshl_add_u32 v5, v8, 4, v5
    v_lshrrev_b32 v7, 1, v2
    v_lshl_add_u32 v5, v7, 3, v5
    v_add_u32 v229, v6, v5
    v_add_u32 v229, 73728, v229
    v_and_b32 v5, 31, v1
    v_cmp_gt_u32 vcc, 28, v5
    s_lshl_b32 s50, s41, 1
    v_lshrrev_b32 v6, 2, v5
    v_lshlrev_b32 v6, 1, v6
    v_mov_b32 v7, s50
    v_cndmask_b32 v6, v7, v6, vcc
    v_cndmask_b32 v7, 12, v7, vcc
    v_and_b32 v5, 1, v1
    v_add_u32 v6, v6, v5
    v_bfe_u32 v5, v1, 1, 1
    v_add3_u32 v7, v7, v5, s42
    v_mul_u32_u24 v7, 0xe0, v7
    v_add3_u32 v7, v7, v6, s43
    v_mul_lo_u32 v230, v7, s45
    v_mul_u32_u24 v5, 0x60, v0
    v_add_u32 v230, v230, v5
    s_mov_b32 s92, 0xc09d30fc
    s_mov_b32 s93, s92
    s_mov_b32 s94, 0x3eeff558
    s_mov_b32 s95, s94
    s_add_u32 s72, s50, s42
    s_mul_i32 s72, s72, 224
    s_add_u32 s72, s72, s43
    s_mul_i32 s72, s72, 192
    s_add_u32 s73, s72, 43008
    s_add_u32 s74, s42, 12
    s_mul_i32 s74, s74, 224
    s_add_u32 s74, s74, s43
    s_add_u32 s74, s74, s50
    s_mul_i32 s74, s74, 192
    s_mul_i32 s75, s41, 6720
    s_add_u32 s75, s75, 30720
    s_cmp_lt_u32 s40, 4
    s_cbranch_scc1 L_A
    v_lshrrev_b32 v7, 2, v1
    v_mul_u32_u24 v5, 0x300, v7
    v_lshl_add_u32 v227, v2, 4, v5
    s_and_b32 s50, s40, 3
    s_mul_i32 s55, s50, 3072
    s_and_b32 s54, s40, 1
    s_mul_i32 s54, s54, 36864
    s_lshr_b32 s51, s50, 1
    s_lshl_b32 s51, s51, 6
    s_add_u32 s54, s54, s51
    v_mul_u32_u24 v5, 0xc0, v7
    v_and_b32 v6, 1, v2
    v_lshl_add_u32 v5, v6, 4, v5
    v_lshrrev_b32 v6, 1, v2
    v_mul_u32_u24 v6, 0x60, v6
    v_add_u32 v226, v5, v6
    v_mul_u32_u24 v252, 448, v7
    v_add_u32 v252, 115832, v252
    s_mul_i32 s51, s50, 6144
    v_lshlrev_b32 v5, 6, v7
    v_lshl_add_u32 v5, v2, 3, v5
    v_add_u32 v253, s51, v5
    v_add_u32 v254, 73728, v253
    s_lshr_b32 s51, s50, 1
    s_add_u32 s51, s51, s42
    s_add_u32 s51, s51, 12
    s_mul_i32 s51, s51, 224
    s_add_u32 s51, s51, s43
    s_and_b32 s50, s50, 1
    s_add_u32 s51, s51, s50
    s_add_u32 s51, s51, 12
    s_mul_i32 s51, s51, 192
    v_lshlrev_b32 v5, 3, v1
    v_add_u32 v5, s51, v5
    v_cmp_gt_u32 vcc, 24, v1
    v_mov_b32 v6, s46
    s_nop 0
    v_cndmask_b32 v255, v6, v5, vcc
    s_cmp_lg_u32 s40, 5
    s_cbranch_scc1 L_gz
    v_mov_b32 v176, 0
    v_mov_b32 v177, 0
    v_mov_b32 v178, 0
    v_mov_b32 v179, 0
    v_mul_u32_u24 v20, 544, v1
    v_add_u32 v20, 74880, v20
    s_mov_b32 exec_hi, 0xffff
    ds_write_b128 v20, v[176:179]
    ds_write_b128 v20, v[176:179] offset:272
    s_mov_b64 exec, -1
L_gz:
    s_cmp_lg_u32 s40, 4
    s_cbranch_scc1 L_tz
    v_mul_u32_u24 v5, 43, v1
    v_lshrrev_b32 v5, 9, v5
    v_lshrrev_b32 v0, 5, v1
    v_bfe_u32 v7, v1, 3, 2
    v_lshlrev_b32 v7, 1, v7
    v_bfe_u32 v8, v1, 1, 1
    v_add_u32 v7, v7, v8
    v_bfe_u32 v8, v1, 2, 1
    v_cmp_eq_u32 vcc, v8, v0
    v_mov_b32 v31, 9
    v_and_b32 v8, 1, v1
    v_cndmask_b32 v7, v31, v7, vcc
    v_lshlrev_b32 v8, 4, v8
    s_movk_i32 s50, 0x3f80
    v_lshlrev_b32 v8, v8, s50
    v_cmp_eq_u32 vcc, 0, v7
    v_cmp_eq_u32_e64 s[50:51], 1, v7
    v_mov_b32 v176, 0
    v_mov_b32 v177, 0
    v_cndmask_b32 v20, 0, v8, vcc
    v_cndmask_b32_e64 v21, 0, v8, s[50:51]
    v_cmp_eq_u32 vcc, 2, v7
    v_cmp_eq_u32_e64 s[50:51], 3, v7
    v_mov_b32 v178, 0
    v_mov_b32 v179, 0
    v_cndmask_b32 v22, 0, v8, vcc
    v_cndmask_b32_e64 v23, 0, v8, s[50:51]
    v_cmp_eq_u32 vcc, 4, v7
    v_cmp_eq_u32_e64 s[50:51], 5, v7
    v_mov_b32 v180, 0
    v_mov_b32 v181, 0
    v_cndmask_b32 v24, 0, v8, vcc
    v_cndmask_b32_e64 v25, 0, v8, s[50:51]
    v_cmp_eq_u32 vcc, 6, v7
    v_cmp_eq_u32_e64 s[50:51], 7, v7
    v_mov_b32 v182, 0
    v_mov_b32 v183, 0
    v_cndmask_b32 v26, 0, v8, vcc
    v_cndmask_b32_e64 v27, 0, v8, s[50:51]
    v_and_b32 v7, 31, v1
    v_cmp_gt_u32 vcc, 28, v7
    v_lshrrev_b32 v7, 2, v7
    v_and_b32 v8, 1, v1
    v_lshl_add_u32 v7, v7, 1, v8
    v_mul_u32_u24 v7, 208, v7
    v_bfe_u32 v8, v1, 1, 1
    v_mul_u32_u24 v8, 2944, v8
    v_add_u32 v7, v7, v8
    v_mul_u32_u24 v8, 208, v2
    v_add_u32 v8, 5888, v8
    v_cndmask_b32 v7, v8, v7, vcc
    v_mul_u32_u24 v8, 0x60, v0
    v_add_u32 v28, v7, v8
    v_lshl_add_u32 v29, v5, 4, v9
    v_lshrrev_b32 v7, 1, v5
    v_mul_u32_u24 v7, 42624, v7
    v_add_u32 v30, v7, v9
    v_mov_b32 v31, v9
    v_mov_b32 v184, 0
    v_mov_b32 v185, 0
    v_mov_b32 v186, 0
    v_mov_b32 v187, 0
    v_mov_b32 v188, 0
    v_mov_b32 v189, 0
    v_mov_b32 v190, 0
    v_mov_b32 v191, 0
    ds_write_b128 v225, v[20:23] offset:0
    ds_write_b128 v225, v[24:27] offset:1024
    ds_write_b128 v225, v[28:31] offset:2048
    ds_write_b128 v225, v[176:179] offset:3072
L_tz:
    s_waitcnt lgkmcnt(0)
    v_and_b32 v7, 2, v1
    v_mul_u32_u24 v0, 1344, v7
    v_sub_u32 v0, v13, v0
    v_add_u32 v0, 1344, v0
    v_lshlrev_b32 v7, 4, v7
    v_sub_u32 v8, v14, v7
    v_add_u32 v8, 16, v8
    s_waitcnt vmcnt(0)
    ds_read2_b32 v[192:193], v13 offset0:0 offset1:48
    ds_read2_b32 v[194:195], v13 offset0:96 offset1:144
    ds_read2_b32 v[196:197], v13 offset0:192 offset1:240
    ds_read_b32 v198, v13 offset:1152
    ds_read2_b32 v[200:201], v0 offset0:0 offset1:48
    ds_read2_b32 v[202:203], v0 offset0:96 offset1:144
    ds_read2_b32 v[204:205], v0 offset0:192 offset1:240
    ds_read_b32 v206, v0 offset:1152
    s_waitcnt lgkmcnt(4)
    v_perm_b32 v176, v193, v192, s56
    v_perm_b32 v177, v195, v194, s56
    v_perm_b32 v178, v197, v196, s56
    v_and_b32 v179, 0xffff, v198
    v_lshlrev_b32 v180, 16, v192
    v_perm_b32 v181, v194, v193, s56
    v_perm_b32 v182, v196, v195, s56
    v_perm_b32 v183, v198, v197, s56
    v_perm_b32 v184, v193, v192, s57
    v_perm_b32 v185, v195, v194, s57
    v_perm_b32 v186, v197, v196, s57
    v_lshrrev_b32 v187, 16, v198
    v_and_b32 v188, 0xffff0000, v192
    v_perm_b32 v189, v194, v193, s57
    v_perm_b32 v190, v196, v195, s57
    v_perm_b32 v191, v198, v197, s57
    s_mov_b32 exec_hi, 0xffff
    ds_write_b128 v14, v[176:179] offset:0
    ds_write_b128 v14, v[180:183] offset:128
    ds_write_b128 v14, v[184:187] offset:272
    ds_write_b128 v14, v[188:191] offset:400
    s_mov_b64 exec, -1
    s_waitcnt lgkmcnt(4)
    v_perm_b32 v208, v201, v200, s56
    v_perm_b32 v209, v203, v202, s56
    v_perm_b32 v210, v205, v204, s56
    v_and_b32 v211, 0xffff, v206
    v_lshlrev_b32 v212, 16, v200
    v_perm_b32 v213, v202, v201, s56
    v_perm_b32 v214, v204, v203, s56
    v_perm_b32 v215, v206, v205, s56
    v_perm_b32 v216, v201, v200, s57
    v_perm_b32 v217, v203, v202, s57
    v_perm_b32 v218, v205, v204, s57
    v_lshrrev_b32 v219, 16, v206
    v_and_b32 v220, 0xffff0000, v200
    v_perm_b32 v221, v202, v201, s57
    v_perm_b32 v222, v204, v203, s57
    v_perm_b32 v223, v206, v205, s57
    s_mov_b32 exec_hi, 0xffff
    ds_write_b128 v8, v[208:211] offset:0
    ds_write_b128 v8, v[212:215] offset:128
    ds_write_b128 v8, v[216:219] offset:272
    ds_write_b128 v8, v[220:223] offset:400
    s_mov_b64 exec, -1
    s_add_u32 s47, s59, 0
    s_cmp_lt_u32 s47, 224
    s_cselect_b32 s66, 9633792, 0
    s_mul_i32 s48, s47, 43008
    buffer_load_dwordx4 v[128:131], v10, s[64:67], s48 offen nt
    buffer_load_dwordx4 v[132:135], v11, s[64:67], s48 offen nt
    s_add_u32 s47, s59, 1
    s_cmp_lt_u32 s47, 224
    s_cselect_b32 s66, 9633792, 0
    s_mul_i32 s48, s47, 43008
    buffer_load_dwordx4 v[136:139], v10, s[64:67], s48 offen nt
    buffer_load_dwordx4 v[140:143], v11, s[64:67], s48 offen nt
    s_setprio 1
    s_waitcnt lgkmcnt(0)
    s_barrier
    ds_read_b128 v[32:35], v17 offset:0
    ds_read_b128 v[36:39], v17 offset:16
    ds_read_b64 v[20:21], v18 offset:0
    ds_read_b64 v[22:23], v18 offset:8
    ds_read_b64 v[24:25], v18 offset:16
    ds_read_b64 v[26:27], v18 offset:24
    ds_read_b128 v[40:43], v17 offset:32
    ds_read_b128 v[44:47], v17 offset:48
    ds_read_b64 v[200:201], v18 offset:9408
    ds_read_b64 v[202:203], v18 offset:9416
    ds_read_b64 v[204:205], v18 offset:9424
    ds_read_b64 v[206:207], v18 offset:9432
    ds_read_b128 v[48:51], v17 offset:64
    ds_read_b128 v[52:55], v17 offset:80
    ds_read_b64 v[212:213], v18 offset:18816
    ds_read_b64 v[214:215], v18 offset:18824
    ds_read_b64 v[216:217], v18 offset:18832
    ds_read_b64 v[218:219], v18 offset:18840
    ds_read_b128 v[56:59], v17 offset:96
    ds_read_b128 v[60:63], v17 offset:112
    s_waitcnt lgkmcnt(15)
    v_swap_b32 v33, v36
    v_swap_b32 v35, v38
    s_nop 0
    v_mfma_f32_4x4x4_16b_bf16 v[64:67], v[32:33], v[20:21], 0
    s_add_u32 s47, s59, 4
    s_cmp_lt_u32 s47, 224
    s_cselect_b32 s66, 9633792, 0
    s_mul_i32 s48, s47, 43008
    buffer_load_dwordx4 v[144:147], v10, s[64:67], s48 offen nt
    buffer_load_dwordx4 v[148:151], v11, s[64:67], s48 offen nt
    v_mfma_f32_4x4x4_16b_bf16 v[64:67], v[36:37], v[22:23], v[64:67]
    s_waitcnt lgkmcnt(14)
    s_nop 0
    v_mfma_f32_4x4x4_16b_bf16 v[64:67], v[34:35], v[24:25], v[64:67]
    s_nop 1
    v_mfma_f32_4x4x4_16b_bf16 v[64:67], v[38:39], v[26:27], v[64:67]
    ds_read_b64 v[20:21], v18 offset:28224
    ds_read_b64 v[22:23], v18 offset:28232
    ds_read_b64 v[24:25], v18 offset:28240
    ds_read_b64 v[26:27], v18 offset:28248
    s_waitcnt lgkmcnt(14)
    v_swap_b32 v41, v44
    v_swap_b32 v43, v46
    v_mfma_f32_4x4x4_16b_bf16 v[68:71], v[32:33], v[200:201], 0
    s_add_u32 s47, s59, 5
    s_cmp_lt_u32 s47, 224
    s_cselect_b32 s66, 9633792, 0
    s_mul_i32 s48, s47, 43008
    buffer_load_dwordx4 v[152:155], v10, s[64:67], s48 offen nt
    buffer_load_dwordx4 v[156:159], v11, s[64:67], s48 offen nt
    v_mfma_f32_4x4x4_16b_bf16 v[64:67], v[40:41], v[200:201], v[64:67]
    s_nop 1
    v_mfma_f32_4x4x4_16b_bf16 v[64:67], v[44:45], v[202:203], v[64:67]
    v_mfma_f32_4x4x4_16b_bf16 v[68:71], v[36:37], v[202:203], v[68:71]
    s_waitcnt lgkmcnt(12)
    v_mfma_f32_4x4x4_16b_bf16 v[64:67], v[42:43], v[204:205], v[64:67]
    s_lshr_b32 s47, s2, 3
    s_lshl_b32 s47, s47, 2
    s_add_u32 s47, s47, s58
    s_lshl_b32 s47, s47, 10
    v_add_u32 v7, s47, v9
    v_add_u32 v8, 0xffff2000, v7
    buffer_load_dwordx4 v[244:247], v7, s[24:27], 0 offen
    buffer_load_dwordx4 v[248:251], v8, s[28:31], 0 offen
    v_mfma_f32_4x4x4_16b_bf16 v[68:71], v[34:35], v[204:205], v[68:71]
    v_mfma_f32_4x4x4_16b_bf16 v[64:67], v[46:47], v[206:207], v[64:67]
    s_nop 0
    v_mfma_f32_4x4x4_16b_bf16 v[68:71], v[38:39], v[206:207], v[68:71]
    s_waitcnt lgkmcnt(8)
    v_swap_b32 v49, v52
    v_swap_b32 v51, v54
    v_mfma_f32_4x4x4_16b_bf16 v[72:75], v[32:33], v[212:213], 0
    v_mfma_f32_4x4x4_16b_bf16 v[68:71], v[40:41], v[212:213], v[68:71]
    v_mfma_f32_4x4x4_16b_bf16 v[64:67], v[48:49], v[212:213], v[64:67]
    s_add_u32 s47, s59, 8
    s_cmp_lt_u32 s47, 224
    s_cselect_b32 s66, 9633792, 0
    s_mul_i32 s48, s47, 43008
    buffer_load_dwordx4 v[160:163], v10, s[64:67], s48 offen nt
    buffer_load_dwordx4 v[164:167], v11, s[64:67], s48 offen nt
    v_mfma_f32_4x4x4_16b_bf16 v[64:67], v[52:53], v[214:215], v[64:67]
    v_mfma_f32_4x4x4_16b_bf16 v[68:71], v[44:45], v[214:215], v[68:71]
    v_mfma_f32_4x4x4_16b_bf16 v[72:75], v[36:37], v[214:215], v[72:75]
    s_waitcnt lgkmcnt(6)
    v_mfma_f32_4x4x4_16b_bf16 v[64:67], v[50:51], v[216:217], v[64:67]
    s_add_u32 s47, s59, 9
    s_cmp_lt_u32 s47, 224
    s_cselect_b32 s66, 9633792, 0
    s_mul_i32 s48, s47, 43008
    buffer_load_dwordx4 v[168:171], v10, s[64:67], s48 offen nt
    buffer_load_dwordx4 v[172:175], v11, s[64:67], s48 offen nt
    v_mfma_f32_4x4x4_16b_bf16 v[68:71], v[42:43], v[216:217], v[68:71]
    v_mfma_f32_4x4x4_16b_bf16 v[72:75], v[34:35], v[216:217], v[72:75]
    v_mfma_f32_4x4x4_16b_bf16 v[64:67], v[54:55], v[218:219], v[64:67]
    v_mfma_f32_4x4x4_16b_bf16 v[68:71], v[46:47], v[218:219], v[68:71]
    v_mfma_f32_4x4x4_16b_bf16 v[72:75], v[38:39], v[218:219], v[72:75]
    s_waitcnt lgkmcnt(2)
    v_swap_b32 v57, v60
    v_swap_b32 v59, v62
    v_mfma_f32_4x4x4_16b_bf16 v[76:79], v[32:33], v[20:21], 0
    s_waitcnt vmcnt(10)
    v_perm_b32 v176, v132, v128, s56
    v_mfma_f32_4x4x4_16b_bf16 v[72:75], v[40:41], v[20:21], v[72:75]
    v_perm_b32 v177, v140, v136, s56
    ds_write_b64 v12, v[176:177] offset:0
    v_mfma_f32_4x4x4_16b_bf16 v[68:71], v[48:49], v[20:21], v[68:71]
    v_perm_b32 v178, v132, v128, s57
    v_perm_b32 v179, v140, v136, s57
    v_mfma_f32_4x4x4_16b_bf16 v[64:67], v[56:57], v[20:21], v[64:67]
    ds_write_b64 v12, v[178:179] offset:96
    v_perm_b32 v180, v133, v129, s56
    v_mfma_f32_4x4x4_16b_bf16 v[64:67], v[60:61], v[22:23], v[64:67]
    v_perm_b32 v181, v141, v137, s56
    ds_write_b64 v12, v[180:181] offset:192
    v_mfma_f32_4x4x4_16b_bf16 v[68:71], v[52:53], v[22:23], v[68:71]
    v_perm_b32 v182, v133, v129, s57
    v_perm_b32 v183, v141, v137, s57
    v_mfma_f32_4x4x4_16b_bf16 v[72:75], v[44:45], v[22:23], v[72:75]
    ds_write_b64 v12, v[182:183] offset:288
    v_perm_b32 v184, v134, v130, s56
    v_mfma_f32_4x4x4_16b_bf16 v[76:79], v[36:37], v[22:23], v[76:79]
    v_perm_b32 v185, v142, v138, s56
    ds_write_b64 v12, v[184:185] offset:384
    s_waitcnt lgkmcnt(5)
    v_mfma_f32_4x4x4_16b_bf16 v[64:67], v[58:59], v[24:25], v[64:67]
    v_perm_b32 v186, v134, v130, s57
    v_perm_b32 v187, v142, v138, s57
    v_mfma_f32_4x4x4_16b_bf16 v[68:71], v[50:51], v[24:25], v[68:71]
    ds_write_b64 v12, v[186:187] offset:480
    v_perm_b32 v188, v135, v131, s56
    v_mfma_f32_4x4x4_16b_bf16 v[72:75], v[42:43], v[24:25], v[72:75]
    v_perm_b32 v189, v143, v139, s56
    ds_write_b64 v12, v[188:189] offset:576
    v_mfma_f32_4x4x4_16b_bf16 v[76:79], v[34:35], v[24:25], v[76:79]
    v_perm_b32 v190, v135, v131, s57
    v_perm_b32 v191, v143, v139, s57
    v_mfma_f32_4x4x4_16b_bf16 v[64:67], v[62:63], v[26:27], v[64:67]
    ds_write_b64 v12, v[190:191] offset:672
    v_mfma_f32_4x4x4_16b_bf16 v[68:71], v[54:55], v[26:27], v[68:71]
    v_mfma_f32_4x4x4_16b_bf16 v[72:75], v[46:47], v[26:27], v[72:75]
    v_mfma_f32_4x4x4_16b_bf16 v[76:79], v[38:39], v[26:27], v[76:79]
    s_nop 0
    v_cvt_pk_bf16_f32 v196, v64, v65
    v_cvt_pk_bf16_f32 v197, v66, v67
    s_mov_b64 exec, s[68:69]
    ds_write_b64 v15, v[196:197] offset:0
    s_mov_b64 exec, -1
    s_waitcnt lgkmcnt(0)
    s_barrier
    ds_read_b64 v[200:201], v18 offset:37632
    ds_read_b64 v[202:203], v18 offset:37640
    ds_read_b64 v[204:205], v18 offset:37648
    ds_read_b64 v[206:207], v18 offset:37656
    ds_read_b64 v[212:213], v19 offset:0
    ds_read_b64 v[214:215], v19 offset:8
    ds_read_b64 v[216:217], v19 offset:16
    ds_read_b64 v[218:219], v19 offset:24
    s_waitcnt lgkmcnt(6)
    v_mfma_f32_4x4x4_16b_bf16 v[68:71], v[56:57], v[200:201], v[68:71]
    v_mfma_f32_4x4x4_16b_bf16 v[72:75], v[48:49], v[200:201], v[72:75]
    v_mfma_f32_4x4x4_16b_bf16 v[76:79], v[40:41], v[200:201], v[76:79]
    s_waitcnt vmcnt(6)
    v_perm_b32 v176, v148, v144, s56
    v_mfma_f32_4x4x4_16b_bf16 v[80:83], v[32:33], v[200:201], 0
    v_perm_b32 v177, v156, v152, s56
    ds_write_b64 v12, v[176:177] offset:18816
    v_mfma_f32_4x4x4_16b_bf16 v[68:71], v[60:61], v[202:203], v[68:71]
    v_perm_b32 v178, v148, v144, s57
    v_perm_b32 v179, v156, v152, s57
    v_mfma_f32_4x4x4_16b_bf16 v[72:75], v[52:53], v[202:203], v[72:75]
    ds_write_b64 v12, v[178:179] offset:18912
    v_perm_b32 v180, v149, v145, s56
    v_mfma_f32_4x4x4_16b_bf16 v[76:79], v[44:45], v[202:203], v[76:79]
    v_perm_b32 v181, v157, v153, s56
    ds_write_b64 v12, v[180:181] offset:19008
    v_mfma_f32_4x4x4_16b_bf16 v[80:83], v[36:37], v[202:203], v[80:83]
    v_perm_b32 v182, v149, v145, s57
    v_perm_b32 v183, v157, v153, s57
    s_waitcnt lgkmcnt(7)
    v_mfma_f32_4x4x4_16b_bf16 v[68:71], v[58:59], v[204:205], v[68:71]
    ds_write_b64 v12, v[182:183] offset:19104
    v_perm_b32 v184, v150, v146, s56
    v_mfma_f32_4x4x4_16b_bf16 v[72:75], v[50:51], v[204:205], v[72:75]
    v_perm_b32 v185, v158, v154, s56
    ds_write_b64 v12, v[184:185] offset:19200
    v_mfma_f32_4x4x4_16b_bf16 v[76:79], v[42:43], v[204:205], v[76:79]
    v_perm_b32 v186, v150, v146, s57
    v_perm_b32 v187, v158, v154, s57
    v_mfma_f32_4x4x4_16b_bf16 v[80:83], v[34:35], v[204:205], v[80:83]
    ds_write_b64 v12, v[186:187] offset:19296
    v_perm_b32 v188, v151, v147, s56
    v_mfma_f32_4x4x4_16b_bf16 v[68:71], v[62:63], v[206:207], v[68:71]
    v_perm_b32 v189, v159, v155, s56
    ds_write_b64 v12, v[188:189] offset:19392
    v_mfma_f32_4x4x4_16b_bf16 v[72:75], v[54:55], v[206:207], v[72:75]
    v_perm_b32 v190, v151, v147, s57
    v_perm_b32 v191, v159, v155, s57
    v_mfma_f32_4x4x4_16b_bf16 v[76:79], v[46:47], v[206:207], v[76:79]
    ds_write_b64 v12, v[190:191] offset:19488
    v_mfma_f32_4x4x4_16b_bf16 v[80:83], v[38:39], v[206:207], v[80:83]
    s_waitcnt vmcnt(0)
    v_perm_b32 v176, v164, v160, s56
    s_waitcnt lgkmcnt(10)
    v_mfma_f32_4x4x4_16b_bf16 v[72:75], v[56:57], v[212:213], v[72:75]
    v_perm_b32 v177, v172, v168, s56
    ds_write_b64 v12, v[176:177] offset:37632
    v_mfma_f32_4x4x4_16b_bf16 v[76:79], v[48:49], v[212:213], v[76:79]
    v_cvt_pk_bf16_f32 v192, v68, v69
    v_cvt_pk_bf16_f32 v193, v70, v71
    s_mov_b64 exec, s[68:69]
    ds_write_b64 v15, v[192:193] offset:64
    s_mov_b64 exec, -1
    v_perm_b32 v178, v164, v160, s57
    v_perm_b32 v179, v172, v168, s57
    v_mfma_f32_4x4x4_16b_bf16 v[80:83], v[40:41], v[212:213], v[80:83]
    ds_write_b64 v12, v[178:179] offset:37728
    v_perm_b32 v180, v165, v161, s56
    v_mfma_f32_4x4x4_16b_bf16 v[84:87], v[32:33], v[212:213], 0
    v_perm_b32 v181, v173, v169, s56
    ds_write_b64 v12, v[180:181] offset:37824
    v_mfma_f32_4x4x4_16b_bf16 v[72:75], v[60:61], v[214:215], v[72:75]
    v_perm_b32 v182, v165, v161, s57
    v_perm_b32 v183, v173, v169, s57
    v_mfma_f32_4x4x4_16b_bf16 v[76:79], v[52:53], v[214:215], v[76:79]
    ds_write_b64 v12, v[182:183] offset:37920
    v_perm_b32 v184, v166, v162, s56
    v_mfma_f32_4x4x4_16b_bf16 v[80:83], v[44:45], v[214:215], v[80:83]
    v_perm_b32 v185, v174, v170, s56
    ds_write_b64 v12, v[184:185] offset:38016
    v_mfma_f32_4x4x4_16b_bf16 v[84:87], v[36:37], v[214:215], v[84:87]
    v_perm_b32 v186, v166, v162, s57
    v_perm_b32 v187, v174, v170, s57
    s_waitcnt lgkmcnt(14)
    v_mfma_f32_4x4x4_16b_bf16 v[72:75], v[58:59], v[216:217], v[72:75]
    ds_write_b64 v12, v[186:187] offset:38112
    v_perm_b32 v188, v167, v163, s56
    v_mfma_f32_4x4x4_16b_bf16 v[76:79], v[50:51], v[216:217], v[76:79]
    v_perm_b32 v189, v175, v171, s56
    ds_write_b64 v12, v[188:189] offset:38208
    v_mfma_f32_4x4x4_16b_bf16 v[80:83], v[42:43], v[216:217], v[80:83]
    v_perm_b32 v190, v167, v163, s57
    v_perm_b32 v191, v175, v171, s57
    v_mfma_f32_4x4x4_16b_bf16 v[84:87], v[34:35], v[216:217], v[84:87]
    ds_write_b64 v12, v[190:191] offset:38304
    v_mfma_f32_4x4x4_16b_bf16 v[72:75], v[62:63], v[218:219], v[72:75]
    v_mfma_f32_4x4x4_16b_bf16 v[76:79], v[54:55], v[218:219], v[76:79]
    v_mfma_f32_4x4x4_16b_bf16 v[80:83], v[46:47], v[218:219], v[80:83]
    v_mfma_f32_4x4x4_16b_bf16 v[84:87], v[38:39], v[218:219], v[84:87]
    s_nop 1
    v_cvt_pk_bf16_f32 v196, v72, v73
    v_cvt_pk_bf16_f32 v197, v74, v75
    s_mov_b64 exec, s[68:69]
    ds_write_b64 v15, v[196:197] offset:128
    s_mov_b64 exec, -1
    s_waitcnt lgkmcnt(0)
    s_barrier
    ds_read_b64 v[20:21], v19 offset:9408
    ds_read_b64 v[22:23], v19 offset:9416
    ds_read_b64 v[24:25], v19 offset:9424
    ds_read_b64 v[26:27], v19 offset:9432
    ds_read_b64 v[200:201], v19 offset:18816
    ds_read_b64 v[202:203], v19 offset:18824
    ds_read_b64 v[204:205], v19 offset:18832
    ds_read_b64 v[206:207], v19 offset:18840
    ds_read_b64 v[212:213], v19 offset:28224
    ds_read_b64 v[214:215], v19 offset:28232
    ds_read_b64 v[216:217], v19 offset:28240
    ds_read_b64 v[218:219], v19 offset:28248
    s_waitcnt lgkmcnt(10)
    v_mfma_f32_4x4x4_16b_bf16 v[76:79], v[56:57], v[20:21], v[76:79]
    s_add_u32 m0, s55, 0
    s_add_u32 s52, s54, 0
    buffer_load_dwordx4 v227, s[24:27], s52 offen lds
    v_mfma_f32_4x4x4_16b_bf16 v[80:83], v[48:49], v[20:21], v[80:83]
    v_mfma_f32_4x4x4_16b_bf16 v[84:87], v[40:41], v[20:21], v[84:87]
    v_mfma_f32_4x4x4_16b_bf16 v[88:91], v[32:33], v[20:21], 0
    v_mfma_f32_4x4x4_16b_bf16 v[76:79], v[60:61], v[22:23], v[76:79]
    v_mfma_f32_4x4x4_16b_bf16 v[80:83], v[52:53], v[22:23], v[80:83]
    s_add_u32 m0, s55, 1024
    s_add_u32 s52, s54, 12288
    buffer_load_dwordx4 v227, s[24:27], s52 offen lds
    v_mfma_f32_4x4x4_16b_bf16 v[84:87], v[44:45], v[22:23], v[84:87]
    v_mfma_f32_4x4x4_16b_bf16 v[88:91], v[36:37], v[22:23], v[88:91]
    s_waitcnt lgkmcnt(8)
    v_mfma_f32_4x4x4_16b_bf16 v[76:79], v[58:59], v[24:25], v[76:79]
    v_mfma_f32_4x4x4_16b_bf16 v[80:83], v[50:51], v[24:25], v[80:83]
    v_mfma_f32_4x4x4_16b_bf16 v[84:87], v[42:43], v[24:25], v[84:87]
    s_add_u32 m0, s55, 2048
    s_add_u32 s52, s54, 24576
    buffer_load_dwordx4 v227, s[24:27], s52 offen lds
    v_mfma_f32_4x4x4_16b_bf16 v[88:91], v[34:35], v[24:25], v[88:91]
    v_mfma_f32_4x4x4_16b_bf16 v[76:79], v[62:63], v[26:27], v[76:79]
    v_mfma_f32_4x4x4_16b_bf16 v[80:83], v[54:55], v[26:27], v[80:83]
    v_mfma_f32_4x4x4_16b_bf16 v[84:87], v[46:47], v[26:27], v[84:87]
    v_mfma_f32_4x4x4_16b_bf16 v[88:91], v[38:39], v[26:27], v[88:91]
    s_add_u32 m0, s55, 12288
    s_add_u32 s52, s54, 128
    buffer_load_dwordx4 v227, s[24:27], s52 offen lds
    ds_read_b64 v[20:21], v19 offset:37632
    ds_read_b64 v[22:23], v19 offset:37640
    ds_read_b64 v[24:25], v19 offset:37648
    ds_read_b64 v[26:27], v19 offset:37656
    s_waitcnt lgkmcnt(10)
    v_mfma_f32_4x4x4_16b_bf16 v[80:83], v[56:57], v[200:201], v[80:83]
    v_mfma_f32_4x4x4_16b_bf16 v[84:87], v[48:49], v[200:201], v[84:87]
    v_cvt_pk_bf16_f32 v192, v76, v77
    v_cvt_pk_bf16_f32 v193, v78, v79
    s_mov_b64 exec, s[68:69]
    ds_write_b64 v15, v[192:193] offset:192
    s_mov_b64 exec, -1
    v_mfma_f32_4x4x4_16b_bf16 v[88:91], v[40:41], v[200:201], v[88:91]
    v_mfma_f32_4x4x4_16b_bf16 v[80:83], v[60:61], v[202:203], v[80:83]
    v_mfma_f32_4x4x4_16b_bf16 v[84:87], v[52:53], v[202:203], v[84:87]
    s_add_u32 m0, s55, 13312
    s_add_u32 s52, s54, 12416
    buffer_load_dwordx4 v227, s[24:27], s52 offen lds
    v_mfma_f32_4x4x4_16b_bf16 v[88:91], v[44:45], v[202:203], v[88:91]
    s_waitcnt lgkmcnt(9)
    v_mfma_f32_4x4x4_16b_bf16 v[80:83], v[58:59], v[204:205], v[80:83]
    v_mfma_f32_4x4x4_16b_bf16 v[84:87], v[50:51], v[204:205], v[84:87]
    v_mfma_f32_4x4x4_16b_bf16 v[88:91], v[42:43], v[204:205], v[88:91]
    v_mfma_f32_4x4x4_16b_bf16 v[80:83], v[62:63], v[206:207], v[80:83]
    s_add_u32 m0, s55, 14336
    s_add_u32 s52, s54, 24704
    buffer_load_dwordx4 v227, s[24:27], s52 offen lds
    v_mfma_f32_4x4x4_16b_bf16 v[84:87], v[54:55], v[206:207], v[84:87]
    v_mfma_f32_4x4x4_16b_bf16 v[88:91], v[46:47], v[206:207], v[88:91]
    s_waitcnt lgkmcnt(7)
    v_mfma_f32_4x4x4_16b_bf16 v[84:87], v[56:57], v[212:213], v[84:87]
    v_mfma_f32_4x4x4_16b_bf16 v[88:91], v[48:49], v[212:213], v[88:91]
    s_nop 0
    v_mfma_f32_4x4x4_16b_bf16 v[84:87], v[60:61], v[214:215], v[84:87]
    v_cvt_pk_bf16_f32 v196, v80, v81
    v_cvt_pk_bf16_f32 v197, v82, v83
    s_mov_b64 exec, s[68:69]
    ds_write_b64 v15, v[196:197] offset:256
    s_mov_b64 exec, -1
    v_mfma_f32_4x4x4_16b_bf16 v[88:91], v[52:53], v[214:215], v[88:91]
    s_waitcnt lgkmcnt(6)
    v_mfma_f32_4x4x4_16b_bf16 v[84:87], v[58:59], v[216:217], v[84:87]
    v_mfma_f32_4x4x4_16b_bf16 v[88:91], v[50:51], v[216:217], v[88:91]
    s_nop 0
    v_mfma_f32_4x4x4_16b_bf16 v[84:87], v[62:63], v[218:219], v[84:87]
    v_mfma_f32_4x4x4_16b_bf16 v[88:91], v[54:55], v[218:219], v[88:91]
    s_waitcnt lgkmcnt(4)
    s_nop 0
    v_mfma_f32_4x4x4_16b_bf16 v[88:91], v[56:57], v[20:21], v[88:91]
    s_nop 1
    v_mfma_f32_4x4x4_16b_bf16 v[88:91], v[60:61], v[22:23], v[88:91]
    s_waitcnt lgkmcnt(2)
    s_nop 0
    v_mfma_f32_4x4x4_16b_bf16 v[88:91], v[58:59], v[24:25], v[88:91]
    s_nop 1
    v_mfma_f32_4x4x4_16b_bf16 v[88:91], v[62:63], v[26:27], v[88:91]
    v_cvt_pk_bf16_f32 v192, v84, v85
    v_cvt_pk_bf16_f32 v193, v86, v87
    s_mov_b64 exec, s[68:69]
    ds_write_b64 v15, v[192:193] offset:320
    s_mov_b64 exec, -1
    v_cvt_pk_bf16_f32 v196, v88, v89
    v_cvt_pk_bf16_f32 v197, v90, v91
    s_mov_b64 exec, s[68:69]
    ds_write_b64 v16, v[196:197] offset:0
    s_mov_b64 exec, -1
    s_waitcnt vmcnt(3)
    s_waitcnt lgkmcnt(0)
    s_barrier
    s_setprio 0
    ds_read_b64_tr_b16 v[0:1], v231 offset:0
    ds_read_b64_tr_b16 v[2:3], v231 offset:3584
    ds_read_b64_tr_b16 v[4:5], v231 offset:7168
    ds_read_b64_tr_b16 v[6:7], v231 offset:10752
    ds_read_b64_tr_b16 v[8:9], v231 offset:14336
    ds_read_b64_tr_b16 v[10:11], v231 offset:17920
    ds_read_b64_tr_b16 v[12:13], v231 offset:21504
    ds_read_b64_tr_b16 v[14:15], v231 offset:25088
    ds_read_b64_tr_b16 v[16:17], v231 offset:28672
    ds_read_b64_tr_b16 v[18:19], v231 offset:32256
    ds_read_b64_tr_b16 v[20:21], v231 offset:35840
    ds_read_b64_tr_b16 v[22:23], v231 offset:39424
    v_mov_b32 v88, 0x3f803f80
    v_mov_b32 v89, 0x3f803f80
    v_mov_b32 v90, 0x3f803f80
    v_mov_b32 v91, 0x3f803f80
    s_add_u32 m0, s55, 24576
    s_add_u32 s52, s54, 256
    buffer_load_dwordx4 v227, s[24:27], s52 offen lds
    s_add_u32 m0, s55, 25600
    s_add_u32 s52, s54, 12544
    buffer_load_dwordx4 v227, s[24:27], s52 offen lds
    s_add_u32 m0, s55, 26624
    s_add_u32 s52, s54, 24832
    buffer_load_dwordx4 v227, s[24:27], s52 offen lds
    s_add_u32 m0, s55, 73728
    s_add_u32 s52, s55, 0
    buffer_load_dwordx4 v226, s[28:31], s52 offen lds
    s_add_u32 m0, s55, 74752
    s_add_u32 s52, s55, 32
    buffer_load_dwordx4 v226, s[28:31], s52 offen lds
    s_add_u32 m0, s55, 75776
    s_add_u32 s52, s55, 64
    buffer_load_dwordx4 v226, s[28:31], s52 offen lds
    s_waitcnt lgkmcnt(0)
    ds_read_b64_tr_b16 v[24:25], v228 offset:0
    ds_read_b64_tr_b16 v[26:27], v228 offset:512
    ds_read_b64_tr_b16 v[28:29], v228 offset:1024
    ds_read_b64_tr_b16 v[30:31], v228 offset:1536
    ds_read_b64_tr_b16 v[32:33], v228 offset:2048
    ds_read_b64_tr_b16 v[34:35], v228 offset:2560
    ds_read_b64_tr_b16 v[36:37], v228 offset:3072
    ds_read_b64_tr_b16 v[38:39], v228 offset:3584
    ds_read_b64_tr_b16 v[40:41], v228 offset:4096
    ds_read_b64_tr_b16 v[42:43], v228 offset:4608
    ds_read_b64_tr_b16 v[44:45], v228 offset:5120
    ds_read_b64_tr_b16 v[46:47], v228 offset:5632
    ds_read_b64_tr_b16 v[240:241], v252 offset:0
    ds_read_b64_tr_b16 v[242:243], v252 offset:7168
    ds_read_b64_tr_b16 v[244:245], v252 offset:14336
    ds_read_b64_tr_b16 v[246:247], v252 offset:21504
    ds_read_b64_tr_b16 v[248:249], v252 offset:28672
    ds_read_b64_tr_b16 v[250:251], v252 offset:35840
    v_mfma_f32_32x32x16_bf16 v[72:87], v[88:91], v[0:3], 0
    v_lshlrev_b32 v120, 16, v0
    v_and_b32 v121, 0xffff0000, v0
    v_lshlrev_b32 v122, 16, v1
    v_and_b32 v123, 0xffff0000, v1
    v_lshlrev_b32 v124, 16, v2
    v_and_b32 v125, 0xffff0000, v2
    v_lshlrev_b32 v126, 16, v3
    v_and_b32 v127, 0xffff0000, v3
    v_mfma_f32_32x32x16_bf16 v[72:87], v[88:91], v[4:7], v[72:87]
    v_lshlrev_b32 v128, 16, v4
    v_and_b32 v129, 0xffff0000, v4
    v_lshlrev_b32 v130, 16, v5
    v_and_b32 v131, 0xffff0000, v5
    v_lshlrev_b32 v132, 16, v6
    v_and_b32 v133, 0xffff0000, v6
    v_lshlrev_b32 v134, 16, v7
    v_and_b32 v135, 0xffff0000, v7
    v_mfma_f32_32x32x16_bf16 v[72:87], v[88:91], v[8:11], v[72:87]
    v_lshlrev_b32 v136, 16, v8
    v_and_b32 v137, 0xffff0000, v8
    v_lshlrev_b32 v138, 16, v9
    v_and_b32 v139, 0xffff0000, v9
    v_lshlrev_b32 v140, 16, v10
    v_and_b32 v141, 0xffff0000, v10
    v_lshlrev_b32 v142, 16, v11
    v_and_b32 v143, 0xffff0000, v11
    v_mfma_f32_32x32x16_bf16 v[72:87], v[88:91], v[12:15], v[72:87]
    v_lshlrev_b32 v144, 16, v12
    v_and_b32 v145, 0xffff0000, v12
    v_lshlrev_b32 v146, 16, v13
    v_and_b32 v147, 0xffff0000, v13
    v_lshlrev_b32 v148, 16, v14
    v_and_b32 v149, 0xffff0000, v14
    v_lshlrev_b32 v150, 16, v15
    v_and_b32 v151, 0xffff0000, v15
    v_mfma_f32_32x32x16_bf16 v[72:87], v[88:91], v[16:19], v[72:87]
    v_lshlrev_b32 v152, 16, v16
    v_and_b32 v153, 0xffff0000, v16
    v_lshlrev_b32 v154, 16, v17
    v_and_b32 v155, 0xffff0000, v17
    v_lshlrev_b32 v156, 16, v18
    v_and_b32 v157, 0xffff0000, v18
    v_lshlrev_b32 v158, 16, v19
    v_and_b32 v159, 0xffff0000, v19
    v_mfma_f32_32x32x16_bf16 v[72:87], v[88:91], v[20:23], v[72:87]
    v_lshlrev_b32 v160, 16, v20
    v_and_b32 v161, 0xffff0000, v20
    v_lshlrev_b32 v162, 16, v21
    v_and_b32 v163, 0xffff0000, v21
    v_lshlrev_b32 v164, 16, v22
    v_and_b32 v165, 0xffff0000, v22
    v_lshlrev_b32 v166, 16, v23
    v_and_b32 v167, 0xffff0000, v23
    v_pk_mul_f32 v[118:119], v[120:121], v[120:121]
    v_pk_mul_f32 v[116:117], v[122:123], v[122:123]
    v_pk_fma_f32 v[118:119], v[124:125], v[124:125], v[118:119]
    v_pk_fma_f32 v[116:117], v[126:127], v[126:127], v[116:117]
    v_pk_fma_f32 v[118:119], v[128:129], v[128:129], v[118:119]
    v_pk_fma_f32 v[116:117], v[130:131], v[130:131], v[116:117]
    v_pk_fma_f32 v[118:119], v[132:133], v[132:133], v[118:119]
    v_pk_fma_f32 v[116:117], v[134:135], v[134:135], v[116:117]
    v_pk_fma_f32 v[118:119], v[136:137], v[136:137], v[118:119]
    v_pk_fma_f32 v[116:117], v[138:139], v[138:139], v[116:117]
    v_pk_fma_f32 v[118:119], v[140:141], v[140:141], v[118:119]
    v_pk_fma_f32 v[116:117], v[142:143], v[142:143], v[116:117]
    v_pk_fma_f32 v[118:119], v[144:145], v[144:145], v[118:119]
    v_pk_fma_f32 v[116:117], v[146:147], v[146:147], v[116:117]
    v_pk_fma_f32 v[118:119], v[148:149], v[148:149], v[118:119]
    v_pk_fma_f32 v[116:117], v[150:151], v[150:151], v[116:117]
    v_pk_fma_f32 v[118:119], v[152:153], v[152:153], v[118:119]
    v_pk_fma_f32 v[116:117], v[154:155], v[154:155], v[116:117]
    v_pk_fma_f32 v[118:119], v[156:157], v[156:157], v[118:119]
    v_pk_fma_f32 v[116:117], v[158:159], v[158:159], v[116:117]
    v_pk_fma_f32 v[118:119], v[160:161], v[160:161], v[118:119]
    v_pk_fma_f32 v[116:117], v[162:163], v[162:163], v[116:117]
    v_pk_fma_f32 v[118:119], v[164:165], v[164:165], v[118:119]
    v_pk_fma_f32 v[116:117], v[166:167], v[166:167], v[116:117]
    v_pk_add_f32 v[118:119], v[118:119], v[116:117]
    v_mov_b32 v116, v72
    v_add_f32 v118, v118, v119
    v_add_f32 v119, v118, 0
    s_nop 1
    v_permlane32_swap_b32 v118, v119
    v_add_f32 v118, v118, v119
    v_mul_f32 v116, 0x3c2aaaab, v116
    v_mul_f32 v118, 0x3c2aaaab, v118
    v_fma_f32 v118, -v116, v116, v118
    v_max_f32 v118, 0, v118
    v_add_f32 v118, 0x3727c5ac, v118
    v_rsq_f32 v118, v118
    s_nop 0
    v_mul_f32 v118, 0x3eeff558, v118
    v_mul_f32 v119, v116, v118
    v_sub_f32 v119, 0, v119
    v_pk_fma_f32 v[120:121], v[120:121], v[118:119], v[118:119] op_sel:[0,0,1] op_sel_hi:[1,0,1]
    v_pk_fma_f32 v[122:123], v[122:123], v[118:119], v[118:119] op_sel:[0,0,1] op_sel_hi:[1,0,1]
    v_pk_fma_f32 v[124:125], v[124:125], v[118:119], v[118:119] op_sel:[0,0,1] op_sel_hi:[1,0,1]
    v_pk_fma_f32 v[126:127], v[126:127], v[118:119], v[118:119] op_sel:[0,0,1] op_sel_hi:[1,0,1]
    v_pk_fma_f32 v[128:129], v[128:129], v[118:119], v[118:119] op_sel:[0,0,1] op_sel_hi:[1,0,1]
    v_pk_fma_f32 v[130:131], v[130:131], v[118:119], v[118:119] op_sel:[0,0,1] op_sel_hi:[1,0,1]
    v_pk_fma_f32 v[132:133], v[132:133], v[118:119], v[118:119] op_sel:[0,0,1] op_sel_hi:[1,0,1]
    v_pk_fma_f32 v[134:135], v[134:135], v[118:119], v[118:119] op_sel:[0,0,1] op_sel_hi:[1,0,1]
    v_pk_fma_f32 v[136:137], v[136:137], v[118:119], v[118:119] op_sel:[0,0,1] op_sel_hi:[1,0,1]
    v_pk_fma_f32 v[138:139], v[138:139], v[118:119], v[118:119] op_sel:[0,0,1] op_sel_hi:[1,0,1]
    v_pk_fma_f32 v[140:141], v[140:141], v[118:119], v[118:119] op_sel:[0,0,1] op_sel_hi:[1,0,1]
    v_pk_fma_f32 v[142:143], v[142:143], v[118:119], v[118:119] op_sel:[0,0,1] op_sel_hi:[1,0,1]
    v_pk_fma_f32 v[144:145], v[144:145], v[118:119], v[118:119] op_sel:[0,0,1] op_sel_hi:[1,0,1]
    v_pk_fma_f32 v[146:147], v[146:147], v[118:119], v[118:119] op_sel:[0,0,1] op_sel_hi:[1,0,1]
    v_pk_fma_f32 v[148:149], v[148:149], v[118:119], v[118:119] op_sel:[0,0,1] op_sel_hi:[1,0,1]
    v_pk_fma_f32 v[150:151], v[150:151], v[118:119], v[118:119] op_sel:[0,0,1] op_sel_hi:[1,0,1]
    v_pk_fma_f32 v[152:153], v[152:153], v[118:119], v[118:119] op_sel:[0,0,1] op_sel_hi:[1,0,1]
    v_pk_fma_f32 v[154:155], v[154:155], v[118:119], v[118:119] op_sel:[0,0,1] op_sel_hi:[1,0,1]
    v_pk_fma_f32 v[156:157], v[156:157], v[118:119], v[118:119] op_sel:[0,0,1] op_sel_hi:[1,0,1]
    v_pk_fma_f32 v[158:159], v[158:159], v[118:119], v[118:119] op_sel:[0,0,1] op_sel_hi:[1,0,1]
    v_pk_fma_f32 v[160:161], v[160:161], v[118:119], v[118:119] op_sel:[0,0,1] op_sel_hi:[1,0,1]
    v_pk_fma_f32 v[162:163], v[162:163], v[118:119], v[118:119] op_sel:[0,0,1] op_sel_hi:[1,0,1]
    v_pk_fma_f32 v[164:165], v[164:165], v[118:119], v[118:119] op_sel:[0,0,1] op_sel_hi:[1,0,1]
    v_pk_fma_f32 v[166:167], v[166:167], v[118:119], v[118:119] op_sel:[0,0,1] op_sel_hi:[1,0,1]
    v_cvt_pk_bf16_f32 v0, v120, v121
    v_cvt_pk_bf16_f32 v1, v122, v123
    v_cvt_pk_bf16_f32 v2, v124, v125
    v_cvt_pk_bf16_f32 v3, v126, v127
    v_cvt_pk_bf16_f32 v4, v128, v129
    v_cvt_pk_bf16_f32 v5, v130, v131
    v_cvt_pk_bf16_f32 v6, v132, v133
    v_cvt_pk_bf16_f32 v7, v134, v135
    v_cvt_pk_bf16_f32 v8, v136, v137
    v_cvt_pk_bf16_f32 v9, v138, v139
    v_cvt_pk_bf16_f32 v10, v140, v141
    v_cvt_pk_bf16_f32 v11, v142, v143
    v_cvt_pk_bf16_f32 v12, v144, v145
    v_cvt_pk_bf16_f32 v13, v146, v147
    v_cvt_pk_bf16_f32 v14, v148, v149
    v_cvt_pk_bf16_f32 v15, v150, v151
    v_cvt_pk_bf16_f32 v16, v152, v153
    v_cvt_pk_bf16_f32 v17, v154, v155
    v_cvt_pk_bf16_f32 v18, v156, v157
    v_cvt_pk_bf16_f32 v19, v158, v159
    v_cvt_pk_bf16_f32 v20, v160, v161
    v_cvt_pk_bf16_f32 v21, v162, v163
    v_cvt_pk_bf16_f32 v22, v164, v165
    v_cvt_pk_bf16_f32 v23, v166, v167
    s_waitcnt lgkmcnt(0)
    s_waitcnt vmcnt(6)
    s_barrier
    v_mfma_f32_32x32x16_bf16 v[120:135], v[24:27], v[0:3], 0
    ds_read_b64_tr_b16 v[24:25], v228 offset:12288
    ds_read_b64_tr_b16 v[26:27], v228 offset:12800
    s_add_u32 m0, s55, 36864
    s_add_u32 s52, s54, 384
    buffer_load_dwordx4 v227, s[24:27], s52 offen lds
    v_mfma_f32_32x32x16_bf16 v[120:135], v[28:31], v[4:7], v[120:135]
    ds_read_b64_tr_b16 v[28:29], v228 offset:13312
    ds_read_b64_tr_b16 v[30:31], v228 offset:13824
    s_add_u32 m0, s55, 37888
    s_add_u32 s52, s54, 12672
    buffer_load_dwordx4 v227, s[24:27], s52 offen lds
    v_mfma_f32_32x32x16_bf16 v[120:135], v[32:35], v[8:11], v[120:135]
    ds_read_b64_tr_b16 v[32:33], v228 offset:14336
    ds_read_b64_tr_b16 v[34:35], v228 offset:14848
    s_add_u32 m0, s55, 38912
    s_add_u32 s52, s54, 24960
    buffer_load_dwordx4 v227, s[24:27], s52 offen lds
    v_mfma_f32_32x32x16_bf16 v[120:135], v[36:39], v[12:15], v[120:135]
    ds_read_b64_tr_b16 v[36:37], v228 offset:15360
    ds_read_b64_tr_b16 v[38:39], v228 offset:15872
    v_mfma_f32_32x32x16_bf16 v[120:135], v[40:43], v[16:19], v[120:135]
    ds_read_b64_tr_b16 v[40:41], v228 offset:16384
    ds_read_b64_tr_b16 v[42:43], v228 offset:16896
    v_mfma_f32_32x32x16_bf16 v[120:135], v[44:47], v[20:23], v[120:135]
    ds_read_b64_tr_b16 v[44:45], v228 offset:17408
    ds_read_b64_tr_b16 v[46:47], v228 offset:17920
    v_lshlrev_b32 v140, 16, v240
    v_and_b32 v141, 0xffff0000, v240
    v_lshlrev_b32 v142, 16, v241
    v_and_b32 v143, 0xffff0000, v241
    v_lshlrev_b32 v144, 16, v242
    v_and_b32 v145, 0xffff0000, v242
    v_lshlrev_b32 v146, 16, v243
    v_and_b32 v147, 0xffff0000, v243
    v_lshlrev_b32 v148, 16, v244
    v_and_b32 v149, 0xffff0000, v244
    v_lshlrev_b32 v150, 16, v245
    v_and_b32 v151, 0xffff0000, v245
    v_lshlrev_b32 v152, 16, v246
    v_and_b32 v153, 0xffff0000, v246
    v_lshlrev_b32 v154, 16, v247
    v_and_b32 v155, 0xffff0000, v247
    v_lshlrev_b32 v156, 16, v248
    v_and_b32 v157, 0xffff0000, v248
    v_lshlrev_b32 v158, 16, v249
    v_and_b32 v159, 0xffff0000, v249
    v_lshlrev_b32 v160, 16, v250
    v_and_b32 v161, 0xffff0000, v250
    v_lshlrev_b32 v162, 16, v251
    v_and_b32 v163, 0xffff0000, v251
    v_pk_mul_f32 v[138:139], v[140:141], v[140:141]
    v_pk_fma_f32 v[138:139], v[142:143], v[142:143], v[138:139]
    v_pk_add_f32 v[136:137], v[140:141], v[142:143]
    v_pk_fma_f32 v[138:139], v[144:145], v[144:145], v[138:139]
    v_pk_add_f32 v[136:137], v[136:137], v[144:145]
    v_pk_fma_f32 v[138:139], v[146:147], v[146:147], v[138:139]
    v_pk_add_f32 v[136:137], v[136:137], v[146:147]
    v_pk_fma_f32 v[138:139], v[148:149], v[148:149], v[138:139]
    v_pk_add_f32 v[136:137], v[136:137], v[148:149]
    v_pk_fma_f32 v[138:139], v[150:151], v[150:151], v[138:139]
    v_pk_add_f32 v[136:137], v[136:137], v[150:151]
    v_pk_fma_f32 v[138:139], v[152:153], v[152:153], v[138:139]
    v_pk_add_f32 v[136:137], v[136:137], v[152:153]
    v_pk_fma_f32 v[138:139], v[154:155], v[154:155], v[138:139]
    v_pk_add_f32 v[136:137], v[136:137], v[154:155]
    v_pk_fma_f32 v[138:139], v[156:157], v[156:157], v[138:139]
    v_pk_add_f32 v[136:137], v[136:137], v[156:157]
    v_pk_fma_f32 v[138:139], v[158:159], v[158:159], v[138:139]
    v_pk_add_f32 v[136:137], v[136:137], v[158:159]
    v_pk_fma_f32 v[138:139], v[160:161], v[160:161], v[138:139]
    v_pk_add_f32 v[136:137], v[136:137], v[160:161]
    v_pk_fma_f32 v[138:139], v[162:163], v[162:163], v[138:139]
    v_pk_add_f32 v[136:137], v[136:137], v[162:163]
    v_add_f32 v136, v136, v137
    v_add_f32 v138, v138, v139
    v_mov_b32 v137, v136
    v_mov_b32 v139, v138
    s_nop 0
    v_permlane32_swap_b32 v136, v137
    v_permlane32_swap_b32 v138, v139
    v_add_f32 v136, v136, v137
    v_add_f32 v138, v138, v139
    v_mov_b32 v137, v136
    v_mov_b32 v139, v138
    s_nop 0
    v_permlane16_swap_b32 v136, v137
    v_permlane16_swap_b32 v138, v139
    v_add_f32 v136, v136, v137
    v_add_f32 v138, v138, v139
    v_mul_f32 v136, 0x3c2aaaab, v136
    v_mul_f32 v138, 0x3c2aaaab, v138
    v_fma_f32 v138, -v136, v136, v138
    v_max_f32 v138, 0, v138
    v_add_f32 v138, 0x3727c5ac, v138
    v_rsq_f32 v138, v138
    s_nop 0
    v_mul_f32 v138, 0x3eeff558, v138
    v_mul_f32 v139, v136, v138
    v_sub_f32 v139, 0, v139
    v_pk_fma_f32 v[140:141], v[140:141], v[138:139], v[138:139] op_sel:[0,0,1] op_sel_hi:[1,0,1]
    v_pk_fma_f32 v[142:143], v[142:143], v[138:139], v[138:139] op_sel:[0,0,1] op_sel_hi:[1,0,1]
    v_pk_fma_f32 v[144:145], v[144:145], v[138:139], v[138:139] op_sel:[0,0,1] op_sel_hi:[1,0,1]
    v_pk_fma_f32 v[146:147], v[146:147], v[138:139], v[138:139] op_sel:[0,0,1] op_sel_hi:[1,0,1]
    v_pk_fma_f32 v[148:149], v[148:149], v[138:139], v[138:139] op_sel:[0,0,1] op_sel_hi:[1,0,1]
    v_pk_fma_f32 v[150:151], v[150:151], v[138:139], v[138:139] op_sel:[0,0,1] op_sel_hi:[1,0,1]
    v_pk_fma_f32 v[152:153], v[152:153], v[138:139], v[138:139] op_sel:[0,0,1] op_sel_hi:[1,0,1]
    v_pk_fma_f32 v[154:155], v[154:155], v[138:139], v[138:139] op_sel:[0,0,1] op_sel_hi:[1,0,1]
    v_pk_fma_f32 v[156:157], v[156:157], v[138:139], v[138:139] op_sel:[0,0,1] op_sel_hi:[1,0,1]
    v_pk_fma_f32 v[158:159], v[158:159], v[138:139], v[138:139] op_sel:[0,0,1] op_sel_hi:[1,0,1]
    v_pk_fma_f32 v[160:161], v[160:161], v[138:139], v[138:139] op_sel:[0,0,1] op_sel_hi:[1,0,1]
    v_pk_fma_f32 v[162:163], v[162:163], v[138:139], v[138:139] op_sel:[0,0,1] op_sel_hi:[1,0,1]
    v_cvt_pk_bf16_f32 v240, v140, v141
    v_cvt_pk_bf16_f32 v241, v142, v143
    v_cvt_pk_bf16_f32 v242, v144, v145
    v_cvt_pk_bf16_f32 v243, v146, v147
    v_cvt_pk_bf16_f32 v244, v148, v149
    v_cvt_pk_bf16_f32 v245, v150, v151
    v_cvt_pk_bf16_f32 v246, v152, v153
    v_cvt_pk_bf16_f32 v247, v154, v155
    v_cvt_pk_bf16_f32 v248, v156, v157
    v_cvt_pk_bf16_f32 v249, v158, v159
    v_cvt_pk_bf16_f32 v250, v160, v161
    v_cvt_pk_bf16_f32 v251, v162, v163
    v_pk_fma_f32 v[168:169], v[120:121], v[120:121], s[92:93] neg_lo:[1,0,0] neg_hi:[1,0,0]
    v_pk_fma_f32 v[170:171], v[122:123], v[122:123], s[92:93] neg_lo:[1,0,0] neg_hi:[1,0,0]
    v_pk_fma_f32 v[172:173], v[124:125], v[124:125], s[92:93] neg_lo:[1,0,0] neg_hi:[1,0,0]
    v_pk_fma_f32 v[174:175], v[126:127], v[126:127], s[92:93] neg_lo:[1,0,0] neg_hi:[1,0,0]
    v_pk_fma_f32 v[176:177], v[128:129], v[128:129], s[92:93] neg_lo:[1,0,0] neg_hi:[1,0,0]
    v_pk_fma_f32 v[178:179], v[130:131], v[130:131], s[92:93] neg_lo:[1,0,0] neg_hi:[1,0,0]
    v_pk_fma_f32 v[180:181], v[132:133], v[132:133], s[92:93] neg_lo:[1,0,0] neg_hi:[1,0,0]
    v_pk_fma_f32 v[182:183], v[134:135], v[134:135], s[92:93] neg_lo:[1,0,0] neg_hi:[1,0,0]
    v_pk_mul_f32 v[168:169], v[120:121], v[168:169]
    v_pk_mul_f32 v[170:171], v[122:123], v[170:171]
    v_pk_mul_f32 v[172:173], v[124:125], v[172:173]
    v_pk_mul_f32 v[174:175], v[126:127], v[174:175]
    v_pk_mul_f32 v[176:177], v[128:129], v[176:177]
    v_pk_mul_f32 v[178:179], v[130:131], v[178:179]
    v_pk_mul_f32 v[180:181], v[132:133], v[180:181]
    v_pk_mul_f32 v[182:183], v[134:135], v[182:183]
    s_waitcnt vmcnt(3)
    s_barrier
    s_waitcnt lgkmcnt(0)
    v_mfma_f32_32x32x16_bf16 v[136:151], v[24:27], v[0:3], 0
    ds_read_b64_tr_b16 v[24:25], v228 offset:24576
    ds_read_b64_tr_b16 v[26:27], v228 offset:25088
    s_add_u32 m0, s55, 49152
    s_add_u32 s52, s54, 512
    buffer_load_dwordx4 v227, s[24:27], s52 offen lds
    v_exp_f32 v168, v168
    v_exp_f32 v169, v169
    v_exp_f32 v170, v170
    v_mfma_f32_32x32x16_bf16 v[136:151], v[28:31], v[4:7], v[136:151]
    ds_read_b64_tr_b16 v[28:29], v228 offset:25600
    ds_read_b64_tr_b16 v[30:31], v228 offset:26112
    s_add_u32 m0, s55, 50176
    s_add_u32 s52, s54, 12800
    buffer_load_dwordx4 v227, s[24:27], s52 offen lds
    v_exp_f32 v171, v171
    v_exp_f32 v172, v172
    v_exp_f32 v173, v173
    v_mfma_f32_32x32x16_bf16 v[136:151], v[32:35], v[8:11], v[136:151]
    ds_read_b64_tr_b16 v[32:33], v228 offset:26624
    ds_read_b64_tr_b16 v[34:35], v228 offset:27136
    s_add_u32 m0, s55, 51200
    s_add_u32 s52, s54, 25088
    buffer_load_dwordx4 v227, s[24:27], s52 offen lds
    v_exp_f32 v174, v174
    v_exp_f32 v175, v175
    v_exp_f32 v176, v176
    v_mfma_f32_32x32x16_bf16 v[136:151], v[36:39], v[12:15], v[136:151]
    ds_read_b64_tr_b16 v[36:37], v228 offset:27648
    ds_read_b64_tr_b16 v[38:39], v228 offset:28160
    s_add_u32 m0, s55, 86016
    s_add_u32 s52, s55, 12288
    buffer_load_dwordx4 v226, s[28:31], s52 offen lds
    v_exp_f32 v177, v177
    v_exp_f32 v178, v178
    v_exp_f32 v179, v179
    v_mfma_f32_32x32x16_bf16 v[136:151], v[40:43], v[16:19], v[136:151]
    ds_read_b64_tr_b16 v[40:41], v228 offset:28672
    ds_read_b64_tr_b16 v[42:43], v228 offset:29184
    s_add_u32 m0, s55, 87040
    s_add_u32 s52, s55, 12320
    buffer_load_dwordx4 v226, s[28:31], s52 offen lds
    v_exp_f32 v180, v180
    v_exp_f32 v181, v181
    v_exp_f32 v182, v182
    v_mfma_f32_32x32x16_bf16 v[136:151], v[44:47], v[20:23], v[136:151]
    ds_read_b64_tr_b16 v[44:45], v228 offset:29696
    ds_read_b64_tr_b16 v[46:47], v228 offset:30208
    s_add_u32 m0, s55, 88064
    s_add_u32 s52, s55, 12352
    buffer_load_dwordx4 v226, s[28:31], s52 offen lds
    v_exp_f32 v183, v183
    v_pk_fma_f32 v[168:169], v[168:169], s[94:95], s[94:95]
    v_pk_fma_f32 v[170:171], v[170:171], s[94:95], s[94:95]
    v_pk_fma_f32 v[172:173], v[172:173], s[94:95], s[94:95]
    v_pk_fma_f32 v[174:175], v[174:175], s[94:95], s[94:95]
    v_pk_fma_f32 v[176:177], v[176:177], s[94:95], s[94:95]
    v_pk_fma_f32 v[178:179], v[178:179], s[94:95], s[94:95]
    v_pk_fma_f32 v[180:181], v[180:181], s[94:95], s[94:95]
    v_pk_fma_f32 v[182:183], v[182:183], s[94:95], s[94:95]
    v_pk_fma_f32 v[184:185], v[136:137], v[136:137], s[92:93] neg_lo:[1,0,0] neg_hi:[1,0,0]
    v_pk_fma_f32 v[186:187], v[138:139], v[138:139], s[92:93] neg_lo:[1,0,0] neg_hi:[1,0,0]
    v_pk_fma_f32 v[188:189], v[140:141], v[140:141], s[92:93] neg_lo:[1,0,0] neg_hi:[1,0,0]
    v_pk_fma_f32 v[190:191], v[142:143], v[142:143], s[92:93] neg_lo:[1,0,0] neg_hi:[1,0,0]
    v_pk_fma_f32 v[192:193], v[144:145], v[144:145], s[92:93] neg_lo:[1,0,0] neg_hi:[1,0,0]
    v_pk_fma_f32 v[194:195], v[146:147], v[146:147], s[92:93] neg_lo:[1,0,0] neg_hi:[1,0,0]
    v_pk_fma_f32 v[196:197], v[148:149], v[148:149], s[92:93] neg_lo:[1,0,0] neg_hi:[1,0,0]
    v_pk_fma_f32 v[198:199], v[150:151], v[150:151], s[92:93] neg_lo:[1,0,0] neg_hi:[1,0,0]
    v_pk_mul_f32 v[184:185], v[136:137], v[184:185]
    v_pk_mul_f32 v[186:187], v[138:139], v[186:187]
    v_pk_mul_f32 v[188:189], v[140:141], v[188:189]
    v_pk_mul_f32 v[190:191], v[142:143], v[190:191]
    v_pk_mul_f32 v[192:193], v[144:145], v[192:193]
    v_pk_mul_f32 v[194:195], v[146:147], v[194:195]
    v_pk_mul_f32 v[196:197], v[148:149], v[196:197]
    v_pk_mul_f32 v[198:199], v[150:151], v[198:199]
    s_waitcnt vmcnt(6)
    s_barrier
    s_waitcnt lgkmcnt(0)
    v_mfma_f32_32x32x16_bf16 v[152:167], v[24:27], v[0:3], 0
    ds_read_b64_tr_b16 v[24:25], v228 offset:36864
    ds_read_b64_tr_b16 v[26:27], v228 offset:37376
    ds_read_b64_tr_b16 v[48:49], v229 offset:0
    ds_read_b64_tr_b16 v[50:51], v229 offset:512
    s_add_u32 m0, s55, 61440
    s_add_u32 s52, s54, 640
    buffer_load_dwordx4 v227, s[24:27], s52 offen lds
    v_exp_f32 v184, v184
    v_rcp_f32 v168, v168
    v_exp_f32 v185, v185
    v_mfma_f32_32x32x16_bf16 v[152:167], v[28:31], v[4:7], v[152:167]
    ds_read_b64_tr_b16 v[28:29], v228 offset:37888
    ds_read_b64_tr_b16 v[30:31], v228 offset:38400
    ds_read_b64_tr_b16 v[52:53], v229 offset:1024
    ds_read_b64_tr_b16 v[54:55], v229 offset:1536
    s_add_u32 m0, s55, 62464
    s_add_u32 s52, s54, 12928
    buffer_load_dwordx4 v227, s[24:27], s52 offen lds
    v_rcp_f32 v169, v169
    v_exp_f32 v186, v186
    v_rcp_f32 v170, v170
    v_mfma_f32_32x32x16_bf16 v[152:167], v[32:35], v[8:11], v[152:167]
    ds_read_b64_tr_b16 v[32:33], v228 offset:38912
    ds_read_b64_tr_b16 v[34:35], v228 offset:39424
    ds_read_b64_tr_b16 v[56:57], v229 offset:2048
    ds_read_b64_tr_b16 v[58:59], v229 offset:2560
    s_add_u32 m0, s55, 63488
    s_add_u32 s52, s54, 25216
    buffer_load_dwordx4 v227, s[24:27], s52 offen lds
    v_exp_f32 v187, v187
    v_rcp_f32 v171, v171
    v_exp_f32 v188, v188
    v_mfma_f32_32x32x16_bf16 v[152:167], v[36:39], v[12:15], v[152:167]
    ds_read_b64_tr_b16 v[36:37], v228 offset:39936
    ds_read_b64_tr_b16 v[38:39], v228 offset:40448
    ds_read_b64_tr_b16 v[60:61], v229 offset:3072
    ds_read_b64_tr_b16 v[62:63], v229 offset:3584
    s_add_u32 m0, s55, 98304
    s_add_u32 s52, s55, 24576
    buffer_load_dwordx4 v226, s[28:31], s52 offen lds
    v_rcp_f32 v172, v172
    v_exp_f32 v189, v189
    v_rcp_f32 v173, v173
    v_mfma_f32_32x32x16_bf16 v[152:167], v[40:43], v[16:19], v[152:167]
    ds_read_b64_tr_b16 v[40:41], v228 offset:40960
    ds_read_b64_tr_b16 v[42:43], v228 offset:41472
    ds_read_b64_tr_b16 v[64:65], v229 offset:4096
    ds_read_b64_tr_b16 v[66:67], v229 offset:4608
    s_add_u32 m0, s55, 99328
    s_add_u32 s52, s55, 24608
    buffer_load_dwordx4 v226, s[28:31], s52 offen lds
    v_exp_f32 v190, v190
    v_rcp_f32 v174, v174
    v_exp_f32 v191, v191
    v_mfma_f32_32x32x16_bf16 v[152:167], v[44:47], v[20:23], v[152:167]
    ds_read_b64_tr_b16 v[44:45], v228 offset:41984
    ds_read_b64_tr_b16 v[46:47], v228 offset:42496
    ds_read_b64_tr_b16 v[68:69], v229 offset:5120
    ds_read_b64_tr_b16 v[70:71], v229 offset:5632
    s_add_u32 m0, s55, 100352
    s_add_u32 s52, s55, 24640
    buffer_load_dwordx4 v226, s[28:31], s52 offen lds
    v_rcp_f32 v175, v175
    v_exp_f32 v192, v192
    v_rcp_f32 v176, v176
    v_exp_f32 v193, v193
    v_rcp_f32 v177, v177
    v_exp_f32 v194, v194
    v_rcp_f32 v178, v178
    v_exp_f32 v195, v195
    v_rcp_f32 v179, v179
    v_exp_f32 v196, v196
    v_rcp_f32 v180, v180
    v_exp_f32 v197, v197
    v_rcp_f32 v181, v181
    v_exp_f32 v198, v198
    v_rcp_f32 v182, v182
    v_exp_f32 v199, v199
    v_rcp_f32 v183, v183
    v_pk_mul_f32 v[168:169], v[120:121], v[168:169]
    v_pk_mul_f32 v[170:171], v[122:123], v[170:171]
    v_pk_mul_f32 v[172:173], v[124:125], v[172:173]
    v_pk_mul_f32 v[174:175], v[126:127], v[174:175]
    v_pk_mul_f32 v[176:177], v[128:129], v[176:177]
    v_pk_mul_f32 v[178:179], v[130:131], v[178:179]
    v_pk_mul_f32 v[180:181], v[132:133], v[180:181]
    v_pk_mul_f32 v[182:183], v[134:135], v[182:183]
    v_pk_fma_f32 v[184:185], v[184:185], s[94:95], s[94:95]
    v_pk_fma_f32 v[186:187], v[186:187], s[94:95], s[94:95]
    v_pk_fma_f32 v[188:189], v[188:189], s[94:95], s[94:95]
    v_pk_fma_f32 v[190:191], v[190:191], s[94:95], s[94:95]
    v_pk_fma_f32 v[192:193], v[192:193], s[94:95], s[94:95]
    v_pk_fma_f32 v[194:195], v[194:195], s[94:95], s[94:95]
    v_pk_fma_f32 v[196:197], v[196:197], s[94:95], s[94:95]
    v_pk_fma_f32 v[198:199], v[198:199], s[94:95], s[94:95]
    v_pk_fma_f32 v[200:201], v[152:153], v[152:153], s[92:93] neg_lo:[1,0,0] neg_hi:[1,0,0]
    v_pk_fma_f32 v[202:203], v[154:155], v[154:155], s[92:93] neg_lo:[1,0,0] neg_hi:[1,0,0]
    v_pk_fma_f32 v[204:205], v[156:157], v[156:157], s[92:93] neg_lo:[1,0,0] neg_hi:[1,0,0]
    v_pk_fma_f32 v[206:207], v[158:159], v[158:159], s[92:93] neg_lo:[1,0,0] neg_hi:[1,0,0]
    v_pk_fma_f32 v[208:209], v[160:161], v[160:161], s[92:93] neg_lo:[1,0,0] neg_hi:[1,0,0]
    v_pk_fma_f32 v[210:211], v[162:163], v[162:163], s[92:93] neg_lo:[1,0,0] neg_hi:[1,0,0]
    v_pk_fma_f32 v[212:213], v[164:165], v[164:165], s[92:93] neg_lo:[1,0,0] neg_hi:[1,0,0]
    v_pk_fma_f32 v[214:215], v[166:167], v[166:167], s[92:93] neg_lo:[1,0,0] neg_hi:[1,0,0]
    v_pk_mul_f32 v[200:201], v[152:153], v[200:201]
    v_pk_mul_f32 v[202:203], v[154:155], v[202:203]
    v_pk_mul_f32 v[204:205], v[156:157], v[204:205]
    v_pk_mul_f32 v[206:207], v[158:159], v[206:207]
    v_pk_mul_f32 v[208:209], v[160:161], v[208:209]
    v_pk_mul_f32 v[210:211], v[162:163], v[210:211]
    v_pk_mul_f32 v[212:213], v[164:165], v[212:213]
    v_pk_mul_f32 v[214:215], v[166:167], v[214:215]
    s_waitcnt vmcnt(6)
    s_barrier
    s_waitcnt lgkmcnt(2)
    v_mfma_f32_32x32x16_bf16 v[120:135], v[24:27], v[0:3], 0
    ds_read_b64_tr_b16 v[24:25], v228 offset:49152
    ds_read_b64_tr_b16 v[26:27], v228 offset:49664
    s_add_u32 m0, s55, 110592
    s_add_u32 s52, s55, 36864
    buffer_load_dwordx4 v226, s[28:31], s52 offen lds
    v_cvt_pk_bf16_f32 v216, v168, v169
    v_cvt_pk_bf16_f32 v217, v170, v171
    v_cvt_pk_bf16_f32 v218, v172, v173
    v_cvt_pk_bf16_f32 v219, v174, v175
    v_cvt_pk_bf16_f32 v220, v176, v177
    v_cvt_pk_bf16_f32 v221, v178, v179
    v_mfma_f32_32x32x16_bf16 v[120:135], v[28:31], v[4:7], v[120:135]
    ds_read_b64_tr_b16 v[28:29], v228 offset:50176
    ds_read_b64_tr_b16 v[30:31], v228 offset:50688
    s_add_u32 m0, s55, 111616
    s_add_u32 s52, s55, 36896
    buffer_load_dwordx4 v226, s[28:31], s52 offen lds
    v_cvt_pk_bf16_f32 v222, v180, v181
    v_cvt_pk_bf16_f32 v223, v182, v183
    v_exp_f32 v200, v200
    v_rcp_f32 v184, v184
    v_mfma_f32_32x32x16_bf16 v[120:135], v[32:35], v[8:11], v[120:135]
    ds_read_b64_tr_b16 v[32:33], v228 offset:51200
    ds_read_b64_tr_b16 v[34:35], v228 offset:51712
    s_add_u32 m0, s55, 112640
    s_add_u32 s52, s55, 36928
    buffer_load_dwordx4 v226, s[28:31], s52 offen lds
    v_exp_f32 v201, v201
    v_rcp_f32 v185, v185
    v_exp_f32 v202, v202
    v_mfma_f32_32x32x16_bf16 v[120:135], v[36:39], v[12:15], v[120:135]
    ds_read_b64_tr_b16 v[36:37], v228 offset:52224
    ds_read_b64_tr_b16 v[38:39], v228 offset:52736
    s_add_u32 m0, s55, 122880
    s_add_u32 s52, s55, 49152
    buffer_load_dwordx4 v226, s[28:31], s52 offen lds
    v_rcp_f32 v186, v186
    v_exp_f32 v203, v203
    v_rcp_f32 v187, v187
    v_mfma_f32_32x32x16_bf16 v[120:135], v[40:43], v[16:19], v[120:135]
    ds_read_b64_tr_b16 v[40:41], v228 offset:53248
    ds_read_b64_tr_b16 v[42:43], v228 offset:53760
    s_add_u32 m0, s55, 123904
    s_add_u32 s52, s55, 49184
    buffer_load_dwordx4 v226, s[28:31], s52 offen lds
    v_exp_f32 v204, v204
    v_rcp_f32 v188, v188
    v_exp_f32 v205, v205
    v_mfma_f32_32x32x16_bf16 v[120:135], v[44:47], v[20:23], v[120:135]
    ds_read_b64_tr_b16 v[44:45], v228 offset:54272
    ds_read_b64_tr_b16 v[46:47], v228 offset:54784
    s_add_u32 m0, s55, 124928
    s_add_u32 s52, s55, 49216
    buffer_load_dwordx4 v226, s[28:31], s52 offen lds
    v_rcp_f32 v189, v189
    v_exp_f32 v206, v206
    v_rcp_f32 v190, v190
    s_waitcnt lgkmcnt(12)
    v_mfma_f32_32x32x16_bf16 v[72:87], v[48:51], v[216:219], 0
    ds_read_b64_tr_b16 v[48:49], v229 offset:12288
    ds_read_b64_tr_b16 v[50:51], v229 offset:12800
    v_exp_f32 v207, v207
    v_rcp_f32 v191, v191
    v_exp_f32 v208, v208
    v_mfma_f32_32x32x16_bf16 v[88:103], v[52:55], v[216:219], 0
    ds_read_b64_tr_b16 v[52:53], v229 offset:13312
    ds_read_b64_tr_b16 v[54:55], v229 offset:13824
    v_rcp_f32 v192, v192
    v_exp_f32 v209, v209
    v_rcp_f32 v193, v193
    v_mfma_f32_32x32x16_bf16 v[104:119], v[56:59], v[216:219], 0
    ds_read_b64_tr_b16 v[56:57], v229 offset:14336
    ds_read_b64_tr_b16 v[58:59], v229 offset:14848
    v_exp_f32 v210, v210
    v_rcp_f32 v194, v194
    v_exp_f32 v211, v211
    v_mfma_f32_32x32x16_bf16 v[72:87], v[60:63], v[220:223], v[72:87]
    ds_read_b64_tr_b16 v[60:61], v229 offset:15360
    ds_read_b64_tr_b16 v[62:63], v229 offset:15872
    v_rcp_f32 v195, v195
    v_exp_f32 v212, v212
    v_rcp_f32 v196, v196
    v_mfma_f32_32x32x16_bf16 v[88:103], v[64:67], v[220:223], v[88:103]
    ds_read_b64_tr_b16 v[64:65], v229 offset:16384
    ds_read_b64_tr_b16 v[66:67], v229 offset:16896
    v_exp_f32 v213, v213
    v_rcp_f32 v197, v197
    v_exp_f32 v214, v214
    v_mfma_f32_32x32x16_bf16 v[104:119], v[68:71], v[220:223], v[104:119]
    ds_read_b64_tr_b16 v[68:69], v229 offset:17408
    ds_read_b64_tr_b16 v[70:71], v229 offset:17920
    v_rcp_f32 v198, v198
    v_exp_f32 v215, v215
    v_rcp_f32 v199, v199
    v_pk_mul_f32 v[184:185], v[136:137], v[184:185]
    v_pk_mul_f32 v[186:187], v[138:139], v[186:187]
    v_pk_mul_f32 v[188:189], v[140:141], v[188:189]
    v_pk_mul_f32 v[190:191], v[142:143], v[190:191]
    v_pk_mul_f32 v[192:193], v[144:145], v[192:193]
    v_pk_mul_f32 v[194:195], v[146:147], v[194:195]
    v_pk_mul_f32 v[196:197], v[148:149], v[196:197]
    v_pk_mul_f32 v[198:199], v[150:151], v[198:199]
    v_pk_fma_f32 v[200:201], v[200:201], s[94:95], s[94:95]
    v_pk_fma_f32 v[202:203], v[202:203], s[94:95], s[94:95]
    v_pk_fma_f32 v[204:205], v[204:205], s[94:95], s[94:95]
    v_pk_fma_f32 v[206:207], v[206:207], s[94:95], s[94:95]
    v_pk_fma_f32 v[208:209], v[208:209], s[94:95], s[94:95]
    v_pk_fma_f32 v[210:211], v[210:211], s[94:95], s[94:95]
    v_pk_fma_f32 v[212:213], v[212:213], s[94:95], s[94:95]
    v_pk_fma_f32 v[214:215], v[214:215], s[94:95], s[94:95]
    v_pk_fma_f32 v[168:169], v[120:121], v[120:121], s[92:93] neg_lo:[1,0,0] neg_hi:[1,0,0]
    v_pk_fma_f32 v[170:171], v[122:123], v[122:123], s[92:93] neg_lo:[1,0,0] neg_hi:[1,0,0]
    v_pk_fma_f32 v[172:173], v[124:125], v[124:125], s[92:93] neg_lo:[1,0,0] neg_hi:[1,0,0]
    v_pk_fma_f32 v[174:175], v[126:127], v[126:127], s[92:93] neg_lo:[1,0,0] neg_hi:[1,0,0]
    v_pk_fma_f32 v[176:177], v[128:129], v[128:129], s[92:93] neg_lo:[1,0,0] neg_hi:[1,0,0]
    v_pk_fma_f32 v[178:179], v[130:131], v[130:131], s[92:93] neg_lo:[1,0,0] neg_hi:[1,0,0]
    v_pk_fma_f32 v[180:181], v[132:133], v[132:133], s[92:93] neg_lo:[1,0,0] neg_hi:[1,0,0]
    v_pk_fma_f32 v[182:183], v[134:135], v[134:135], s[92:93] neg_lo:[1,0,0] neg_hi:[1,0,0]
    v_pk_mul_f32 v[168:169], v[120:121], v[168:169]
    v_pk_mul_f32 v[170:171], v[122:123], v[170:171]
    v_pk_mul_f32 v[172:173], v[124:125], v[172:173]
    v_pk_mul_f32 v[174:175], v[126:127], v[174:175]
    v_pk_mul_f32 v[176:177], v[128:129], v[176:177]
    v_pk_mul_f32 v[178:179], v[130:131], v[178:179]
    v_pk_mul_f32 v[180:181], v[132:133], v[180:181]
    v_pk_mul_f32 v[182:183], v[134:135], v[182:183]
    s_waitcnt vmcnt(6)
    s_barrier
    s_waitcnt lgkmcnt(12)
    v_mfma_f32_32x32x16_bf16 v[136:151], v[24:27], v[0:3], 0
    v_add_u32 v228, 0xf000, v228
    ds_read_b64_tr_b16 v[24:25], v228 offset:0
    ds_read_b64_tr_b16 v[26:27], v228 offset:512
    s_add_u32 m0, s55, 135168
    s_add_u32 s52, s55, 61440
    buffer_load_dwordx4 v226, s[28:31], s52 offen lds
    v_cvt_pk_bf16_f32 v216, v184, v185
    v_cvt_pk_bf16_f32 v217, v186, v187
    v_cvt_pk_bf16_f32 v218, v188, v189
    v_cvt_pk_bf16_f32 v219, v190, v191
    v_cvt_pk_bf16_f32 v220, v192, v193
    v_cvt_pk_bf16_f32 v221, v194, v195
    v_mfma_f32_32x32x16_bf16 v[136:151], v[28:31], v[4:7], v[136:151]
    ds_read_b64_tr_b16 v[28:29], v228 offset:1024
    ds_read_b64_tr_b16 v[30:31], v228 offset:1536
    s_add_u32 m0, s55, 136192
    s_add_u32 s52, s55, 61472
    buffer_load_dwordx4 v226, s[28:31], s52 offen lds
    v_cvt_pk_bf16_f32 v222, v196, v197
    v_cvt_pk_bf16_f32 v223, v198, v199
    v_exp_f32 v168, v168
    v_rcp_f32 v200, v200
    v_mfma_f32_32x32x16_bf16 v[136:151], v[32:35], v[8:11], v[136:151]
    ds_read_b64_tr_b16 v[32:33], v228 offset:2048
    ds_read_b64_tr_b16 v[34:35], v228 offset:2560
    s_add_u32 m0, s55, 137216
    s_add_u32 s52, s55, 61504
    buffer_load_dwordx4 v226, s[28:31], s52 offen lds
    v_exp_f32 v169, v169
    v_rcp_f32 v201, v201
    v_exp_f32 v170, v170
    v_mfma_f32_32x32x16_bf16 v[136:151], v[36:39], v[12:15], v[136:151]
    ds_read_b64_tr_b16 v[36:37], v228 offset:3072
    ds_read_b64_tr_b16 v[38:39], v228 offset:3584
    v_rcp_f32 v202, v202
    v_exp_f32 v171, v171
    v_rcp_f32 v203, v203
    v_mfma_f32_32x32x16_bf16 v[136:151], v[40:43], v[16:19], v[136:151]
    ds_read_b64_tr_b16 v[40:41], v228 offset:4096
    ds_read_b64_tr_b16 v[42:43], v228 offset:4608
    v_exp_f32 v172, v172
    v_rcp_f32 v204, v204
    v_exp_f32 v173, v173
    v_mfma_f32_32x32x16_bf16 v[136:151], v[44:47], v[20:23], v[136:151]
    ds_read_b64_tr_b16 v[44:45], v228 offset:5120
    ds_read_b64_tr_b16 v[46:47], v228 offset:5632
    v_rcp_f32 v205, v205
    v_exp_f32 v174, v174
    v_rcp_f32 v206, v206
    s_waitcnt lgkmcnt(12)
    v_mfma_f32_32x32x16_bf16 v[72:87], v[48:51], v[216:219], v[72:87]
    ds_read_b64_tr_b16 v[48:49], v229 offset:24576
    ds_read_b64_tr_b16 v[50:51], v229 offset:25088
    v_exp_f32 v175, v175
    v_rcp_f32 v207, v207
    v_exp_f32 v176, v176
    v_mfma_f32_32x32x16_bf16 v[88:103], v[52:55], v[216:219], v[88:103]
    ds_read_b64_tr_b16 v[52:53], v229 offset:25600
    ds_read_b64_tr_b16 v[54:55], v229 offset:26112
    v_rcp_f32 v208, v208
    v_exp_f32 v177, v177
    v_rcp_f32 v209, v209
    v_mfma_f32_32x32x16_bf16 v[104:119], v[56:59], v[216:219], v[104:119]
    ds_read_b64_tr_b16 v[56:57], v229 offset:26624
    ds_read_b64_tr_b16 v[58:59], v229 offset:27136
    v_exp_f32 v178, v178
    v_rcp_f32 v210, v210
    v_exp_f32 v179, v179
    v_mfma_f32_32x32x16_bf16 v[72:87], v[60:63], v[220:223], v[72:87]
    ds_read_b64_tr_b16 v[60:61], v229 offset:27648
    ds_read_b64_tr_b16 v[62:63], v229 offset:28160
    v_rcp_f32 v211, v211
    v_exp_f32 v180, v180
    v_rcp_f32 v212, v212
    v_mfma_f32_32x32x16_bf16 v[88:103], v[64:67], v[220:223], v[88:103]
    ds_read_b64_tr_b16 v[64:65], v229 offset:28672
    ds_read_b64_tr_b16 v[66:67], v229 offset:29184
    v_exp_f32 v181, v181
    v_rcp_f32 v213, v213
    v_exp_f32 v182, v182
    v_mfma_f32_32x32x16_bf16 v[104:119], v[68:71], v[220:223], v[104:119]
    ds_read_b64_tr_b16 v[68:69], v229 offset:29696
    ds_read_b64_tr_b16 v[70:71], v229 offset:30208
    v_rcp_f32 v214, v214
    v_exp_f32 v183, v183
    v_rcp_f32 v215, v215
    v_pk_mul_f32 v[200:201], v[152:153], v[200:201]
    v_pk_mul_f32 v[202:203], v[154:155], v[202:203]
    v_pk_mul_f32 v[204:205], v[156:157], v[204:205]
    v_pk_mul_f32 v[206:207], v[158:159], v[206:207]
    v_pk_mul_f32 v[208:209], v[160:161], v[208:209]
    v_pk_mul_f32 v[210:211], v[162:163], v[210:211]
    v_pk_mul_f32 v[212:213], v[164:165], v[212:213]
    v_pk_mul_f32 v[214:215], v[166:167], v[214:215]
    v_pk_fma_f32 v[168:169], v[168:169], s[94:95], s[94:95]
    v_pk_fma_f32 v[170:171], v[170:171], s[94:95], s[94:95]
    v_pk_fma_f32 v[172:173], v[172:173], s[94:95], s[94:95]
    v_pk_fma_f32 v[174:175], v[174:175], s[94:95], s[94:95]
    v_pk_fma_f32 v[176:177], v[176:177], s[94:95], s[94:95]
    v_pk_fma_f32 v[178:179], v[178:179], s[94:95], s[94:95]
    v_pk_fma_f32 v[180:181], v[180:181], s[94:95], s[94:95]
    v_pk_fma_f32 v[182:183], v[182:183], s[94:95], s[94:95]
    v_pk_fma_f32 v[184:185], v[136:137], v[136:137], s[92:93] neg_lo:[1,0,0] neg_hi:[1,0,0]
    v_pk_fma_f32 v[186:187], v[138:139], v[138:139], s[92:93] neg_lo:[1,0,0] neg_hi:[1,0,0]
    v_pk_fma_f32 v[188:189], v[140:141], v[140:141], s[92:93] neg_lo:[1,0,0] neg_hi:[1,0,0]
    v_pk_fma_f32 v[190:191], v[142:143], v[142:143], s[92:93] neg_lo:[1,0,0] neg_hi:[1,0,0]
    v_pk_fma_f32 v[192:193], v[144:145], v[144:145], s[92:93] neg_lo:[1,0,0] neg_hi:[1,0,0]
    v_pk_fma_f32 v[194:195], v[146:147], v[146:147], s[92:93] neg_lo:[1,0,0] neg_hi:[1,0,0]
    v_pk_fma_f32 v[196:197], v[148:149], v[148:149], s[92:93] neg_lo:[1,0,0] neg_hi:[1,0,0]
    v_pk_fma_f32 v[198:199], v[150:151], v[150:151], s[92:93] neg_lo:[1,0,0] neg_hi:[1,0,0]
    v_pk_mul_f32 v[184:185], v[136:137], v[184:185]
    v_pk_mul_f32 v[186:187], v[138:139], v[186:187]
    v_pk_mul_f32 v[188:189], v[140:141], v[188:189]
    v_pk_mul_f32 v[190:191], v[142:143], v[190:191]
    v_pk_mul_f32 v[192:193], v[144:145], v[192:193]
    v_pk_mul_f32 v[194:195], v[146:147], v[194:195]
    v_pk_mul_f32 v[196:197], v[148:149], v[196:197]
    v_pk_mul_f32 v[198:199], v[150:151], v[198:199]
    s_waitcnt vmcnt(6)
    s_barrier
    s_waitcnt lgkmcnt(12)
    v_mfma_f32_32x32x16_bf16 v[152:167], v[24:27], v[0:3], 0
    ds_read_b64_tr_b16 v[24:25], v253 offset:0
    ds_read_b64_tr_b16 v[26:27], v253 offset:1024
    v_cvt_pk_bf16_f32 v216, v200, v201
    v_cvt_pk_bf16_f32 v217, v202, v203
    v_cvt_pk_bf16_f32 v218, v204, v205
    v_cvt_pk_bf16_f32 v219, v206, v207
    v_cvt_pk_bf16_f32 v220, v208, v209
    v_cvt_pk_bf16_f32 v221, v210, v211
    v_mfma_f32_32x32x16_bf16 v[152:167], v[28:31], v[4:7], v[152:167]
    ds_read_b64_tr_b16 v[28:29], v253 offset:2048
    ds_read_b64_tr_b16 v[30:31], v253 offset:3072
    v_cvt_pk_bf16_f32 v222, v212, v213
    v_cvt_pk_bf16_f32 v223, v214, v215
    v_exp_f32 v184, v184
    v_rcp_f32 v168, v168
    v_mfma_f32_32x32x16_bf16 v[152:167], v[32:35], v[8:11], v[152:167]
    ds_read_b64_tr_b16 v[32:33], v253 offset:4096
    ds_read_b64_tr_b16 v[34:35], v253 offset:5120
    v_exp_f32 v185, v185
    v_rcp_f32 v169, v169
    v_exp_f32 v186, v186
    v_mfma_f32_32x32x16_bf16 v[152:167], v[36:39], v[12:15], v[152:167]
    ds_read_b64_tr_b16 v[36:37], v253 offset:32
    ds_read_b64_tr_b16 v[38:39], v253 offset:1056
    v_rcp_f32 v170, v170
    v_exp_f32 v187, v187
    v_rcp_f32 v171, v171
    v_mfma_f32_32x32x16_bf16 v[152:167], v[40:43], v[16:19], v[152:167]
    ds_read_b64_tr_b16 v[40:41], v253 offset:2080
    ds_read_b64_tr_b16 v[42:43], v253 offset:3104
    v_exp_f32 v188, v188
    v_rcp_f32 v172, v172
    v_exp_f32 v189, v189
    v_mfma_f32_32x32x16_bf16 v[152:167], v[44:47], v[20:23], v[152:167]
    ds_read_b64_tr_b16 v[44:45], v253 offset:4128
    ds_read_b64_tr_b16 v[46:47], v253 offset:5152
    v_rcp_f32 v173, v173
    v_exp_f32 v190, v190
    v_rcp_f32 v174, v174
    s_waitcnt lgkmcnt(12)
    v_mfma_f32_32x32x16_bf16 v[72:87], v[48:51], v[216:219], v[72:87]
    ds_read_b64_tr_b16 v[48:49], v229 offset:36864
    ds_read_b64_tr_b16 v[50:51], v229 offset:37376
    v_exp_f32 v191, v191
    v_rcp_f32 v175, v175
    v_exp_f32 v192, v192
    v_mfma_f32_32x32x16_bf16 v[88:103], v[52:55], v[216:219], v[88:103]
    ds_read_b64_tr_b16 v[52:53], v229 offset:37888
    ds_read_b64_tr_b16 v[54:55], v229 offset:38400
    v_rcp_f32 v176, v176
    v_exp_f32 v193, v193
    v_rcp_f32 v177, v177
    v_mfma_f32_32x32x16_bf16 v[104:119], v[56:59], v[216:219], v[104:119]
    ds_read_b64_tr_b16 v[56:57], v229 offset:38912
    ds_read_b64_tr_b16 v[58:59], v229 offset:39424
    v_exp_f32 v194, v194
    v_rcp_f32 v178, v178
    v_exp_f32 v195, v195
    v_mfma_f32_32x32x16_bf16 v[72:87], v[60:63], v[220:223], v[72:87]
    ds_read_b64_tr_b16 v[60:61], v229 offset:39936
    ds_read_b64_tr_b16 v[62:63], v229 offset:40448
    v_rcp_f32 v179, v179
    v_exp_f32 v196, v196
    v_rcp_f32 v180, v180
    v_mfma_f32_32x32x16_bf16 v[88:103], v[64:67], v[220:223], v[88:103]
    ds_read_b64_tr_b16 v[64:65], v229 offset:40960
    ds_read_b64_tr_b16 v[66:67], v229 offset:41472
    v_exp_f32 v197, v197
    v_rcp_f32 v181, v181
    v_exp_f32 v198, v198
    v_mfma_f32_32x32x16_bf16 v[104:119], v[68:71], v[220:223], v[104:119]
    ds_read_b64_tr_b16 v[68:69], v229 offset:41984
    ds_read_b64_tr_b16 v[70:71], v229 offset:42496
    v_rcp_f32 v182, v182
    v_exp_f32 v199, v199
    v_rcp_f32 v183, v183
    v_pk_mul_f32 v[168:169], v[120:121], v[168:169]
    v_pk_mul_f32 v[170:171], v[122:123], v[170:171]
    v_pk_mul_f32 v[172:173], v[124:125], v[172:173]
    v_pk_mul_f32 v[174:175], v[126:127], v[174:175]
    v_pk_mul_f32 v[176:177], v[128:129], v[176:177]
    v_pk_mul_f32 v[178:179], v[130:131], v[178:179]
    v_pk_mul_f32 v[180:181], v[132:133], v[180:181]
    v_pk_mul_f32 v[182:183], v[134:135], v[182:183]
    v_pk_fma_f32 v[184:185], v[184:185], s[94:95], s[94:95]
    v_pk_fma_f32 v[186:187], v[186:187], s[94:95], s[94:95]
    v_pk_fma_f32 v[188:189], v[188:189], s[94:95], s[94:95]
    v_pk_fma_f32 v[190:191], v[190:191], s[94:95], s[94:95]
    v_pk_fma_f32 v[192:193], v[192:193], s[94:95], s[94:95]
    v_pk_fma_f32 v[194:195], v[194:195], s[94:95], s[94:95]
    v_pk_fma_f32 v[196:197], v[196:197], s[94:95], s[94:95]
    v_pk_fma_f32 v[198:199], v[198:199], s[94:95], s[94:95]
    v_pk_fma_f32 v[200:201], v[152:153], v[152:153], s[92:93] neg_lo:[1,0,0] neg_hi:[1,0,0]
    v_pk_fma_f32 v[202:203], v[154:155], v[154:155], s[92:93] neg_lo:[1,0,0] neg_hi:[1,0,0]
    v_pk_fma_f32 v[204:205], v[156:157], v[156:157], s[92:93] neg_lo:[1,0,0] neg_hi:[1,0,0]
    v_pk_fma_f32 v[206:207], v[158:159], v[158:159], s[92:93] neg_lo:[1,0,0] neg_hi:[1,0,0]
    v_pk_fma_f32 v[208:209], v[160:161], v[160:161], s[92:93] neg_lo:[1,0,0] neg_hi:[1,0,0]
    v_pk_fma_f32 v[210:211], v[162:163], v[162:163], s[92:93] neg_lo:[1,0,0] neg_hi:[1,0,0]
    v_pk_fma_f32 v[212:213], v[164:165], v[164:165], s[92:93] neg_lo:[1,0,0] neg_hi:[1,0,0]
    v_pk_fma_f32 v[214:215], v[166:167], v[166:167], s[92:93] neg_lo:[1,0,0] neg_hi:[1,0,0]
    v_pk_mul_f32 v[200:201], v[152:153], v[200:201]
    v_pk_mul_f32 v[202:203], v[154:155], v[202:203]
    v_pk_mul_f32 v[204:205], v[156:157], v[204:205]
    v_pk_mul_f32 v[206:207], v[158:159], v[206:207]
    v_pk_mul_f32 v[208:209], v[160:161], v[208:209]
    v_pk_mul_f32 v[210:211], v[162:163], v[210:211]
    v_pk_mul_f32 v[212:213], v[164:165], v[212:213]
    v_pk_mul_f32 v[214:215], v[166:167], v[214:215]
    s_waitcnt vmcnt(3)
    s_barrier
    s_waitcnt lgkmcnt(12)
    v_mfma_f32_16x16x32_bf16 v[120:123], v[24:27], v[240:243], 0
    ds_read_b64_tr_b16 v[24:25], v253 offset:24576
    ds_read_b64_tr_b16 v[26:27], v253 offset:25600
    v_cvt_pk_bf16_f32 v216, v168, v169
    v_cvt_pk_bf16_f32 v217, v170, v171
    v_mfma_f32_16x16x32_bf16 v[120:123], v[28:31], v[244:247], v[120:123]
    ds_read_b64_tr_b16 v[28:29], v253 offset:26624
    ds_read_b64_tr_b16 v[30:31], v253 offset:27648
    v_cvt_pk_bf16_f32 v218, v172, v173
    v_cvt_pk_bf16_f32 v219, v174, v175
    v_mfma_f32_16x16x32_bf16 v[120:123], v[32:35], v[248:251], v[120:123]
    ds_read_b64_tr_b16 v[32:33], v253 offset:28672
    ds_read_b64_tr_b16 v[34:35], v253 offset:29696
    v_cvt_pk_bf16_f32 v220, v176, v177
    v_cvt_pk_bf16_f32 v221, v178, v179
    v_mfma_f32_16x16x32_bf16 v[124:127], v[36:39], v[240:243], 0
    ds_read_b64_tr_b16 v[36:37], v253 offset:24608
    ds_read_b64_tr_b16 v[38:39], v253 offset:25632
    v_cvt_pk_bf16_f32 v222, v180, v181
    v_cvt_pk_bf16_f32 v223, v182, v183
    v_mfma_f32_16x16x32_bf16 v[124:127], v[40:43], v[244:247], v[124:127]
    ds_read_b64_tr_b16 v[40:41], v253 offset:26656
    ds_read_b64_tr_b16 v[42:43], v253 offset:27680
    v_exp_f32 v200, v200
    v_mfma_f32_16x16x32_bf16 v[124:127], v[44:47], v[248:251], v[124:127]
    ds_read_b64_tr_b16 v[44:45], v253 offset:28704
    ds_read_b64_tr_b16 v[46:47], v253 offset:29728
    v_rcp_f32 v184, v184
    s_waitcnt lgkmcnt(12)
    v_mfma_f32_32x32x16_bf16 v[72:87], v[48:51], v[216:219], v[72:87]
    ds_read_b64_tr_b16 v[48:49], v229 offset:49152
    ds_read_b64_tr_b16 v[50:51], v229 offset:49664
    v_exp_f32 v201, v201
    v_rcp_f32 v185, v185
    v_exp_f32 v202, v202
    v_mfma_f32_32x32x16_bf16 v[88:103], v[52:55], v[216:219], v[88:103]
    ds_read_b64_tr_b16 v[52:53], v229 offset:50176
    ds_read_b64_tr_b16 v[54:55], v229 offset:50688
    v_rcp_f32 v186, v186
    v_exp_f32 v203, v203
    v_rcp_f32 v187, v187
    v_mfma_f32_32x32x16_bf16 v[104:119], v[56:59], v[216:219], v[104:119]
    ds_read_b64_tr_b16 v[56:57], v229 offset:51200
    ds_read_b64_tr_b16 v[58:59], v229 offset:51712
    v_exp_f32 v204, v204
    v_rcp_f32 v188, v188
    v_exp_f32 v205, v205
    s_waitcnt lgkmcnt(6)
    v_mfma_f32_16x16x32_bf16 v[128:131], v[24:27], v[240:243], 0
    ds_read_b64_tr_b16 v[24:25], v253 offset:49152
    ds_read_b64_tr_b16 v[26:27], v253 offset:50176
    v_rcp_f32 v189, v189
    v_mfma_f32_16x16x32_bf16 v[128:131], v[28:31], v[244:247], v[128:131]
    ds_read_b64_tr_b16 v[28:29], v253 offset:51200
    ds_read_b64_tr_b16 v[30:31], v253 offset:52224
    v_exp_f32 v206, v206
    v_mfma_f32_16x16x32_bf16 v[128:131], v[32:35], v[248:251], v[128:131]
    ds_read_b64_tr_b16 v[32:33], v253 offset:53248
    ds_read_b64_tr_b16 v[34:35], v253 offset:54272
    v_rcp_f32 v190, v190
    v_mfma_f32_16x16x32_bf16 v[132:135], v[36:39], v[240:243], 0
    ds_read_b64_tr_b16 v[36:37], v253 offset:49184
    ds_read_b64_tr_b16 v[38:39], v253 offset:50208
    v_exp_f32 v207, v207
    v_mfma_f32_16x16x32_bf16 v[132:135], v[40:43], v[244:247], v[132:135]
    ds_read_b64_tr_b16 v[40:41], v253 offset:51232
    ds_read_b64_tr_b16 v[42:43], v253 offset:52256
    v_rcp_f32 v191, v191
    v_mfma_f32_16x16x32_bf16 v[132:135], v[44:47], v[248:251], v[132:135]
    ds_read_b64_tr_b16 v[44:45], v253 offset:53280
    ds_read_b64_tr_b16 v[46:47], v253 offset:54304
    v_exp_f32 v208, v208
    v_mfma_f32_32x32x16_bf16 v[72:87], v[60:63], v[220:223], v[72:87]
    ds_read_b64_tr_b16 v[60:61], v229 offset:52224
    ds_read_b64_tr_b16 v[62:63], v229 offset:52736
    v_rcp_f32 v192, v192
    v_exp_f32 v209, v209
    v_rcp_f32 v193, v193
    v_mfma_f32_32x32x16_bf16 v[88:103], v[64:67], v[220:223], v[88:103]
    ds_read_b64_tr_b16 v[64:65], v229 offset:53248
    ds_read_b64_tr_b16 v[66:67], v229 offset:53760
    v_exp_f32 v210, v210
    v_rcp_f32 v194, v194
    v_exp_f32 v211, v211
    v_mfma_f32_32x32x16_bf16 v[104:119], v[68:71], v[220:223], v[104:119]
    ds_read_b64_tr_b16 v[68:69], v229 offset:54272
    ds_read_b64_tr_b16 v[70:71], v229 offset:54784
    v_rcp_f32 v195, v195
    v_exp_f32 v212, v212
    v_rcp_f32 v196, v196
    s_waitcnt lgkmcnt(6)
    v_mfma_f32_16x16x32_bf16 v[0:3], v[24:27], v[240:243], 0
    v_exp_f32 v213, v213
    v_mfma_f32_16x16x32_bf16 v[0:3], v[28:31], v[244:247], v[0:3]
    v_rcp_f32 v197, v197
    v_mfma_f32_16x16x32_bf16 v[0:3], v[32:35], v[248:251], v[0:3]
    v_exp_f32 v214, v214
    v_mfma_f32_16x16x32_bf16 v[4:7], v[36:39], v[240:243], 0
    v_rcp_f32 v198, v198
    v_mfma_f32_16x16x32_bf16 v[4:7], v[40:43], v[244:247], v[4:7]
    v_exp_f32 v215, v215
    v_mfma_f32_16x16x32_bf16 v[4:7], v[44:47], v[248:251], v[4:7]
    v_rcp_f32 v199, v199
    v_pk_mul_f32 v[184:185], v[136:137], v[184:185]
    v_pk_mul_f32 v[186:187], v[138:139], v[186:187]
    v_pk_mul_f32 v[188:189], v[140:141], v[188:189]
    v_pk_mul_f32 v[190:191], v[142:143], v[190:191]
    v_pk_mul_f32 v[192:193], v[144:145], v[192:193]
    v_pk_mul_f32 v[194:195], v[146:147], v[194:195]
    v_pk_mul_f32 v[196:197], v[148:149], v[196:197]
    v_pk_mul_f32 v[198:199], v[150:151], v[198:199]
    v_pk_fma_f32 v[200:201], v[200:201], s[94:95], s[94:95]
    v_pk_fma_f32 v[202:203], v[202:203], s[94:95], s[94:95]
    v_pk_fma_f32 v[204:205], v[204:205], s[94:95], s[94:95]
    v_pk_fma_f32 v[206:207], v[206:207], s[94:95], s[94:95]
    v_pk_fma_f32 v[208:209], v[208:209], s[94:95], s[94:95]
    v_pk_fma_f32 v[210:211], v[210:211], s[94:95], s[94:95]
    v_pk_fma_f32 v[212:213], v[212:213], s[94:95], s[94:95]
    v_pk_fma_f32 v[214:215], v[214:215], s[94:95], s[94:95]
    v_pk_fma_f32 v[168:169], v[120:121], v[120:121], s[92:93] neg_lo:[1,0,0] neg_hi:[1,0,0]
    v_pk_fma_f32 v[170:171], v[122:123], v[122:123], s[92:93] neg_lo:[1,0,0] neg_hi:[1,0,0]
    v_pk_fma_f32 v[172:173], v[124:125], v[124:125], s[92:93] neg_lo:[1,0,0] neg_hi:[1,0,0]
    v_pk_fma_f32 v[174:175], v[126:127], v[126:127], s[92:93] neg_lo:[1,0,0] neg_hi:[1,0,0]
    v_pk_fma_f32 v[176:177], v[128:129], v[128:129], s[92:93] neg_lo:[1,0,0] neg_hi:[1,0,0]
    v_pk_fma_f32 v[178:179], v[130:131], v[130:131], s[92:93] neg_lo:[1,0,0] neg_hi:[1,0,0]
    v_pk_fma_f32 v[180:181], v[132:133], v[132:133], s[92:93] neg_lo:[1,0,0] neg_hi:[1,0,0]
    v_pk_fma_f32 v[182:183], v[134:135], v[134:135], s[92:93] neg_lo:[1,0,0] neg_hi:[1,0,0]
    v_pk_fma_f32 v[8:9], v[0:1], v[0:1], s[92:93] neg_lo:[1,0,0] neg_hi:[1,0,0]
    v_pk_fma_f32 v[10:11], v[2:3], v[2:3], s[92:93] neg_lo:[1,0,0] neg_hi:[1,0,0]
    v_pk_fma_f32 v[12:13], v[4:5], v[4:5], s[92:93] neg_lo:[1,0,0] neg_hi:[1,0,0]
    v_pk_fma_f32 v[14:15], v[6:7], v[6:7], s[92:93] neg_lo:[1,0,0] neg_hi:[1,0,0]
    v_pk_mul_f32 v[168:169], v[120:121], v[168:169]
    v_pk_mul_f32 v[170:171], v[122:123], v[170:171]
    v_pk_mul_f32 v[172:173], v[124:125], v[172:173]
    v_pk_mul_f32 v[174:175], v[126:127], v[174:175]
    v_pk_mul_f32 v[176:177], v[128:129], v[176:177]
    v_pk_mul_f32 v[178:179], v[130:131], v[178:179]
    v_pk_mul_f32 v[180:181], v[132:133], v[180:181]
    v_pk_mul_f32 v[182:183], v[134:135], v[182:183]
    v_pk_mul_f32 v[8:9], v[0:1], v[8:9]
    v_pk_mul_f32 v[10:11], v[2:3], v[10:11]
    v_pk_mul_f32 v[12:13], v[4:5], v[12:13]
    v_pk_mul_f32 v[14:15], v[6:7], v[14:15]
    s_waitcnt vmcnt(0)
    s_barrier
    buffer_load_dwordx2 v[22:23], v255, s[16:19], 0 offen
    s_cmp_eq_u32 s44, 0
    s_cbranch_scc1 L_nxb
    buffer_load_dwordx4 v[232:235], v230, s[16:19], 0 offen offset:0
    buffer_load_dwordx4 v[236:239], v230, s[16:19], 0 offen offset:16
    buffer_load_dwordx4 v[240:243], v230, s[16:19], 0 offen offset:32
    buffer_load_dwordx4 v[244:247], v230, s[16:19], 0 offen offset:48
    buffer_load_dwordx4 v[248:251], v230, s[16:19], 0 offen offset:64
    buffer_load_dwordx4 v[16:19], v230, s[16:19], 0 offen offset:80
L_nxb:
    s_waitcnt lgkmcnt(0)
    v_cvt_pk_bf16_f32 v216, v184, v185
    v_cvt_pk_bf16_f32 v217, v186, v187
    v_cvt_pk_bf16_f32 v218, v188, v189
    v_cvt_pk_bf16_f32 v219, v190, v191
    v_cvt_pk_bf16_f32 v220, v192, v193
    v_cvt_pk_bf16_f32 v221, v194, v195
    v_cvt_pk_bf16_f32 v222, v196, v197
    v_cvt_pk_bf16_f32 v223, v198, v199
    v_mfma_f32_32x32x16_bf16 v[72:87], v[48:51], v[216:219], v[72:87]
    v_add_u32 v229, 0xf000, v229
    ds_read_b64_tr_b16 v[48:49], v229 offset:0
    ds_read_b64_tr_b16 v[50:51], v229 offset:512
    ds_read_b64_tr_b16 v[24:25], v254 offset:0
    ds_read_b64_tr_b16 v[26:27], v254 offset:3072
    v_exp_f32 v168, v168
    v_rcp_f32 v200, v200
    v_exp_f32 v169, v169
    v_mfma_f32_32x32x16_bf16 v[88:103], v[52:55], v[216:219], v[88:103]
    ds_read_b64_tr_b16 v[52:53], v229 offset:1024
    ds_read_b64_tr_b16 v[54:55], v229 offset:1536
    ds_read_b64_tr_b16 v[28:29], v254 offset:32
    ds_read_b64_tr_b16 v[30:31], v254 offset:3104
    v_rcp_f32 v201, v201
    v_exp_f32 v170, v170
    v_rcp_f32 v202, v202
    v_mfma_f32_32x32x16_bf16 v[104:119], v[56:59], v[216:219], v[104:119]
    ds_read_b64_tr_b16 v[56:57], v229 offset:2048
    ds_read_b64_tr_b16 v[58:59], v229 offset:2560
    ds_read_b64_tr_b16 v[32:33], v254 offset:1024
    ds_read_b64_tr_b16 v[34:35], v254 offset:4096
    v_exp_f32 v171, v171
    v_rcp_f32 v203, v203
    v_exp_f32 v172, v172
    v_mfma_f32_32x32x16_bf16 v[72:87], v[60:63], v[220:223], v[72:87]
    ds_read_b64_tr_b16 v[60:61], v229 offset:3072
    ds_read_b64_tr_b16 v[62:63], v229 offset:3584
    ds_read_b64_tr_b16 v[36:37], v254 offset:1056
    ds_read_b64_tr_b16 v[38:39], v254 offset:4128
    v_rcp_f32 v204, v204
    v_exp_f32 v173, v173
    v_rcp_f32 v205, v205
    v_mfma_f32_32x32x16_bf16 v[88:103], v[64:67], v[220:223], v[88:103]
    ds_read_b64_tr_b16 v[64:65], v229 offset:4096
    ds_read_b64_tr_b16 v[66:67], v229 offset:4608
    ds_read_b64_tr_b16 v[40:41], v254 offset:2048
    ds_read_b64_tr_b16 v[42:43], v254 offset:5120
    v_exp_f32 v174, v174
    v_rcp_f32 v206, v206
    v_exp_f32 v175, v175
    v_mfma_f32_32x32x16_bf16 v[104:119], v[68:71], v[220:223], v[104:119]
    ds_read_b64_tr_b16 v[68:69], v229 offset:5120
    ds_read_b64_tr_b16 v[70:71], v229 offset:5632
    ds_read_b64_tr_b16 v[44:45], v254 offset:2080
    ds_read_b64_tr_b16 v[46:47], v254 offset:5152
    v_rcp_f32 v207, v207
    v_exp_f32 v176, v176
    v_rcp_f32 v208, v208
    v_exp_f32 v177, v177
    v_rcp_f32 v209, v209
    v_exp_f32 v178, v178
    v_rcp_f32 v210, v210
    v_exp_f32 v179, v179
    v_rcp_f32 v211, v211
    v_exp_f32 v180, v180
    v_rcp_f32 v212, v212
    v_exp_f32 v181, v181
    v_rcp_f32 v213, v213
    v_exp_f32 v182, v182
    v_rcp_f32 v214, v214
    v_exp_f32 v183, v183
    v_rcp_f32 v215, v215
    v_exp_f32 v8, v8
    v_exp_f32 v9, v9
    v_exp_f32 v10, v10
    v_exp_f32 v11, v11
    v_exp_f32 v12, v12
    v_exp_f32 v13, v13
    v_exp_f32 v14, v14
    v_exp_f32 v15, v15
    v_pk_mul_f32 v[200:201], v[152:153], v[200:201]
    v_pk_mul_f32 v[202:203], v[154:155], v[202:203]
    v_pk_mul_f32 v[204:205], v[156:157], v[204:205]
    v_pk_mul_f32 v[206:207], v[158:159], v[206:207]
    v_pk_mul_f32 v[208:209], v[160:161], v[208:209]
    v_pk_mul_f32 v[210:211], v[162:163], v[210:211]
    v_pk_mul_f32 v[212:213], v[164:165], v[212:213]
    v_pk_mul_f32 v[214:215], v[166:167], v[214:215]
    v_pk_fma_f32 v[168:169], v[168:169], s[94:95], s[94:95]
    v_pk_fma_f32 v[170:171], v[170:171], s[94:95], s[94:95]
    v_pk_fma_f32 v[172:173], v[172:173], s[94:95], s[94:95]
    v_pk_fma_f32 v[174:175], v[174:175], s[94:95], s[94:95]
    v_pk_fma_f32 v[176:177], v[176:177], s[94:95], s[94:95]
    v_pk_fma_f32 v[178:179], v[178:179], s[94:95], s[94:95]
    v_pk_fma_f32 v[180:181], v[180:181], s[94:95], s[94:95]
    v_pk_fma_f32 v[182:183], v[182:183], s[94:95], s[94:95]
    v_pk_fma_f32 v[8:9], v[8:9], s[94:95], s[94:95]
    v_pk_fma_f32 v[10:11], v[10:11], s[94:95], s[94:95]
    v_pk_fma_f32 v[12:13], v[12:13], s[94:95], s[94:95]
    v_pk_fma_f32 v[14:15], v[14:15], s[94:95], s[94:95]
    s_barrier
    s_waitcnt lgkmcnt(2)
    v_cvt_pk_bf16_f32 v216, v200, v201
    v_cvt_pk_bf16_f32 v217, v202, v203
    v_cvt_pk_bf16_f32 v218, v204, v205
    v_cvt_pk_bf16_f32 v219, v206, v207
    v_cvt_pk_bf16_f32 v220, v208, v209
    v_cvt_pk_bf16_f32 v221, v210, v211
    v_cvt_pk_bf16_f32 v222, v212, v213
    v_cvt_pk_bf16_f32 v223, v214, v215
    v_mfma_f32_32x32x16_bf16 v[72:87], v[48:51], v[216:219], v[72:87]
    ds_read_b64_tr_b16 v[48:49], v254 offset:49152
    ds_read_b64_tr_b16 v[50:51], v254 offset:52224
    ds_read_b64_tr_b16 v[184:185], v254 offset:24576
    ds_read_b64_tr_b16 v[186:187], v254 offset:27648
    ds_read_b128 v[200:203], v225 offset:0
    ds_read_b128 v[204:207], v225 offset:1024
    ds_read_b128 v[208:211], v225 offset:2048
    v_rcp_f32 v168, v168
    v_rcp_f32 v169, v169
    v_rcp_f32 v170, v170
    v_mfma_f32_32x32x16_bf16 v[88:103], v[52:55], v[216:219], v[88:103]
    ds_read_b64_tr_b16 v[52:53], v254 offset:49184
    ds_read_b64_tr_b16 v[54:55], v254 offset:52256
    ds_read_b64_tr_b16 v[188:189], v254 offset:24608
    ds_read_b64_tr_b16 v[190:191], v254 offset:27680
    v_rcp_f32 v171, v171
    v_rcp_f32 v172, v172
    v_rcp_f32 v173, v173
    v_mfma_f32_32x32x16_bf16 v[104:119], v[56:59], v[216:219], v[104:119]
    ds_read_b64_tr_b16 v[56:57], v254 offset:50176
    ds_read_b64_tr_b16 v[58:59], v254 offset:53248
    ds_read_b64_tr_b16 v[192:193], v254 offset:25600
    ds_read_b64_tr_b16 v[194:195], v254 offset:28672
    v_rcp_f32 v174, v174
    v_rcp_f32 v175, v175
    v_rcp_f32 v176, v176
    v_mfma_f32_32x32x16_bf16 v[72:87], v[60:63], v[220:223], v[72:87]
    ds_read_b64_tr_b16 v[60:61], v254 offset:50208
    ds_read_b64_tr_b16 v[62:63], v254 offset:53280
    ds_read_b64_tr_b16 v[196:197], v254 offset:25632
    ds_read_b64_tr_b16 v[198:199], v254 offset:28704
    v_rcp_f32 v177, v177
    v_rcp_f32 v178, v178
    v_rcp_f32 v179, v179
    v_mfma_f32_32x32x16_bf16 v[88:103], v[64:67], v[220:223], v[88:103]
    ds_read_b64_tr_b16 v[64:65], v254 offset:51200
    ds_read_b64_tr_b16 v[66:67], v254 offset:54272
    ds_read_b64_tr_b16 v[160:161], v254 offset:26624
    ds_read_b64_tr_b16 v[162:163], v254 offset:29696
    v_rcp_f32 v180, v180
    v_rcp_f32 v181, v181
    v_rcp_f32 v182, v182
    v_mfma_f32_32x32x16_bf16 v[104:119], v[68:71], v[220:223], v[104:119]
    ds_read_b64_tr_b16 v[68:69], v254 offset:51232
    ds_read_b64_tr_b16 v[70:71], v254 offset:54304
    ds_read_b64_tr_b16 v[164:165], v254 offset:26656
    ds_read_b64_tr_b16 v[166:167], v254 offset:29728
    v_rcp_f32 v183, v183
    v_rcp_f32 v8, v8
    v_rcp_f32 v9, v9
    v_rcp_f32 v10, v10
    v_rcp_f32 v11, v11
    v_rcp_f32 v12, v12
    v_rcp_f32 v13, v13
    v_rcp_f32 v14, v14
    v_rcp_f32 v15, v15
    s_cmp_eq_u32 s44, 0
    s_cbranch_scc1 L_ngb
    s_waitcnt vmcnt(0)
    s_waitcnt lgkmcnt(15)
    v_mfma_f32_32x32x16_bf16 v[72:87], v[200:203], v[232:235], v[72:87]
    v_mfma_f32_32x32x16_bf16 v[72:87], v[204:207], v[236:239], v[72:87]
    v_mfma_f32_32x32x16_bf16 v[88:103], v[200:203], v[240:243], v[88:103]
    v_mfma_f32_32x32x16_bf16 v[88:103], v[204:207], v[244:247], v[88:103]
    v_mfma_f32_32x32x16_bf16 v[104:119], v[200:203], v[248:251], v[104:119]
    v_mfma_f32_32x32x16_bf16 v[104:119], v[204:207], v[16:19], v[104:119]
L_ngb:
    v_pk_mul_f32 v[168:169], v[120:121], v[168:169]
    v_pk_mul_f32 v[170:171], v[122:123], v[170:171]
    v_pk_mul_f32 v[172:173], v[124:125], v[172:173]
    v_pk_mul_f32 v[174:175], v[126:127], v[174:175]
    v_pk_mul_f32 v[176:177], v[128:129], v[176:177]
    v_pk_mul_f32 v[178:179], v[130:131], v[178:179]
    v_pk_mul_f32 v[180:181], v[132:133], v[180:181]
    v_pk_mul_f32 v[182:183], v[134:135], v[182:183]
    v_pk_mul_f32 v[8:9], v[0:1], v[8:9]
    v_pk_mul_f32 v[10:11], v[2:3], v[10:11]
    v_pk_mul_f32 v[12:13], v[4:5], v[12:13]
    v_pk_mul_f32 v[14:15], v[6:7], v[14:15]
    s_setprio 3
    v_mbcnt_lo_u32_b32 v228, -1, 0
    v_mbcnt_hi_u32_b32 v228, -1, v228
    s_sub_u32 s75, s41, 4
    s_mul_i32 s75, s75, 12288
    v_lshl_add_u32 v229, v228, 4, s75
    s_waitcnt lgkmcnt(0)
    s_cmp_eq_u32 s44, 0
    s_cbranch_scc1 L_nw
    ds_write_b128 v229, v[72:75] offset:0
    ds_write_b128 v229, v[76:79] offset:1024
    ds_write_b128 v229, v[80:83] offset:2048
    ds_write_b128 v229, v[84:87] offset:3072
    ds_write_b128 v229, v[88:91] offset:4096
    ds_write_b128 v229, v[92:95] offset:5120
    ds_write_b128 v229, v[96:99] offset:6144
    ds_write_b128 v229, v[100:103] offset:7168
    ds_write_b128 v229, v[104:107] offset:8192
    ds_write_b128 v229, v[108:111] offset:9216
    ds_write_b128 v229, v[112:115] offset:10240
    ds_write_b128 v229, v[116:119] offset:11264
L_nw:
    s_and_b32 s47, s40, 3
    v_and_b32 v230, 15, v228
    v_mul_u32_u24 v230, 0x180, v230
    v_lshrrev_b32 v231, 4, v228
    v_lshl_add_u32 v230, v231, 4, v230
    s_mul_i32 s52, s47, 1536
    s_add_u32 s52, s52, 24576
    v_add_u32 v230, s52, v230
    s_mul_i32 s52, s47, 384
    s_add_u32 s52, s52, 24576
    v_min_u32 v231, 23, v228
    v_lshl_add_u32 v231, v231, 4, s52
    s_lshl_b32 s52, s47, 2
    s_add_u32 s52, s52, 161472
    v_mov_b32 v226, s52
    v_mov_b32 v227, 161472
    v_cvt_pk_bf16_f32 v212, v168, v169
    v_cvt_pk_bf16_f32 v213, v170, v171
    v_cvt_pk_bf16_f32 v214, v172, v173
    v_cvt_pk_bf16_f32 v215, v174, v175
    v_cvt_pk_bf16_f32 v216, v176, v177
    v_cvt_pk_bf16_f32 v217, v178, v179
    v_cvt_pk_bf16_f32 v218, v180, v181
    v_cvt_pk_bf16_f32 v219, v182, v183
    v_cvt_pk_bf16_f32 v220, v8, v9
    v_cvt_pk_bf16_f32 v221, v10, v11
    v_cvt_pk_bf16_f32 v222, v12, v13
    v_cvt_pk_bf16_f32 v223, v14, v15
    v_mfma_f32_16x16x32_bf16 v[136:139], v[24:27], v[212:215], 0
    v_mfma_f32_16x16x32_bf16 v[140:143], v[28:31], v[212:215], 0
    v_mfma_f32_16x16x32_bf16 v[144:147], v[32:35], v[212:215], 0
    v_mfma_f32_16x16x32_bf16 v[148:151], v[36:39], v[212:215], 0
    v_mfma_f32_16x16x32_bf16 v[152:155], v[40:43], v[212:215], 0
    v_mfma_f32_16x16x32_bf16 v[156:159], v[44:47], v[212:215], 0
    v_mfma_f32_16x16x32_bf16 v[136:139], v[184:187], v[216:219], v[136:139]
    v_mfma_f32_16x16x32_bf16 v[140:143], v[188:191], v[216:219], v[140:143]
    v_mfma_f32_16x16x32_bf16 v[144:147], v[192:195], v[216:219], v[144:147]
    v_mfma_f32_16x16x32_bf16 v[148:151], v[196:199], v[216:219], v[148:151]
    v_mfma_f32_16x16x32_bf16 v[152:155], v[160:163], v[216:219], v[152:155]
    v_mfma_f32_16x16x32_bf16 v[156:159], v[164:167], v[216:219], v[156:159]
    v_mfma_f32_16x16x32_bf16 v[136:139], v[48:51], v[220:223], v[136:139]
    v_mfma_f32_16x16x32_bf16 v[140:143], v[52:55], v[220:223], v[140:143]
    v_mfma_f32_16x16x32_bf16 v[144:147], v[56:59], v[220:223], v[144:147]
    v_mfma_f32_16x16x32_bf16 v[148:151], v[60:63], v[220:223], v[148:151]
    v_mfma_f32_16x16x32_bf16 v[152:155], v[64:67], v[220:223], v[152:155]
    v_mfma_f32_16x16x32_bf16 v[156:159], v[68:71], v[220:223], v[156:159]
    s_mov_b32 exec_lo, 0x000f000f
    s_mov_b32 exec_hi, 0x000f000f
    s_nop 0
    ds_write_b128 v230, v[136:139] offset:0
    ds_write_b128 v230, v[140:143] offset:192
    ds_write_b128 v230, v[144:147] offset:64
    ds_write_b128 v230, v[148:151] offset:256
    ds_write_b128 v230, v[152:155] offset:128
    ds_write_b128 v230, v[156:159] offset:320
    s_mov_b64 exec, -1
    v_mov_b32 v0, 1
    s_waitcnt lgkmcnt(0)
    ds_write_b32 v226, v0
    v_add_u32 v208, s75, v208
    v_add_u32 v209, s75, v209
    s_waitcnt vmcnt(0)
    v_lshlrev_b32 v48, 16, v22
    v_and_b32 v49, 0xffff0000, v22
    v_lshlrev_b32 v50, 16, v23
    v_and_b32 v51, 0xffff0000, v23
L_poll:
    ds_read_b128 v[4:7], v227
    s_waitcnt lgkmcnt(0)
    v_and_b32 v4, v4, v5
    v_and_b32 v6, v6, v7
    v_and_b32 v4, v4, v6
    s_nop 0
    v_readfirstlane_b32 s52, v4
    s_cmp_eq_u32 s52, 1
    s_cbranch_scc1 L_go
    s_sleep 1
    s_branch L_poll
L_go:
    ds_read_b128 v[0:3], v231 offset:0
    ds_read_b128 v[4:7], v231 offset:1536
    ds_read_b128 v[8:11], v231 offset:3072
    ds_read_b128 v[12:15], v231 offset:4608
    s_cmp_lg_u32 s44, 0
    s_cbranch_scc1 L_nrp
    ds_read_b128 v[24:27], v229 offset:0
    ds_read_b128 v[28:31], v229 offset:1024
    ds_read_b128 v[32:35], v229 offset:2048
    ds_read_b128 v[36:39], v229 offset:3072
    ds_read_b128 v[40:43], v229 offset:4096
    ds_read_b128 v[44:47], v229 offset:5120
    ds_read_b128 v[144:147], v229 offset:6144
    ds_read_b128 v[148:151], v229 offset:7168
    ds_read_b128 v[152:155], v229 offset:8192
    ds_read_b128 v[156:159], v229 offset:9216
    ds_read_b128 v[160:163], v229 offset:10240
    ds_read_b128 v[164:167], v229 offset:11264
    s_waitcnt lgkmcnt(12)
    s_branch L_rp
L_nrp:
    s_waitcnt lgkmcnt(0)
L_rp:
    v_add_f32 v48, v48, v0
    v_add_f32 v49, v49, v1
    v_add_f32 v50, v50, v2
    v_add_f32 v51, v51, v3
    v_add_f32 v48, v48, v4
    v_add_f32 v49, v49, v5
    v_add_f32 v50, v50, v6
    v_add_f32 v51, v51, v7
    v_add_f32 v48, v48, v8
    v_add_f32 v49, v49, v9
    v_add_f32 v50, v50, v10
    v_add_f32 v51, v51, v11
    v_add_f32 v48, v48, v12
    v_add_f32 v49, v49, v13
    v_add_f32 v50, v50, v14
    v_add_f32 v51, v51, v15
    v_cvt_pk_bf16_f32 v52, v48, v49
    v_cvt_pk_bf16_f32 v53, v50, v51
    buffer_store_dwordx2 v[52:53], v255, s[32:35], 0 offen sc1 nt
    s_cmp_lg_u32 s44, 0
    s_cbranch_scc1 L_bd
    s_waitcnt lgkmcnt(0)
    v_pk_add_f32 v[72:73], v[72:73], v[24:25]
    v_pk_add_f32 v[74:75], v[74:75], v[26:27]
    v_pk_add_f32 v[76:77], v[76:77], v[28:29]
    v_pk_add_f32 v[78:79], v[78:79], v[30:31]
    v_pk_add_f32 v[80:81], v[80:81], v[32:33]
    v_pk_add_f32 v[82:83], v[82:83], v[34:35]
    v_pk_add_f32 v[84:85], v[84:85], v[36:37]
    v_pk_add_f32 v[86:87], v[86:87], v[38:39]
    v_cvt_pk_bf16_f32 v120, v72, v73
    v_cvt_pk_bf16_f32 v121, v74, v75
    v_cvt_pk_bf16_f32 v122, v76, v77
    v_cvt_pk_bf16_f32 v123, v78, v79
    v_cvt_pk_bf16_f32 v124, v80, v81
    v_cvt_pk_bf16_f32 v125, v82, v83
    v_cvt_pk_bf16_f32 v126, v84, v85
    v_cvt_pk_bf16_f32 v127, v86, v87
    ds_write_b128 v208, v[120:123] offset:0
    ds_write_b128 v208, v[124:127] offset:16
    v_pk_add_f32 v[88:89], v[88:89], v[40:41]
    v_pk_add_f32 v[90:91], v[90:91], v[42:43]
    v_pk_add_f32 v[92:93], v[92:93], v[44:45]
    v_pk_add_f32 v[94:95], v[94:95], v[46:47]
    v_pk_add_f32 v[96:97], v[96:97], v[144:145]
    v_pk_add_f32 v[98:99], v[98:99], v[146:147]
    v_pk_add_f32 v[100:101], v[100:101], v[148:149]
    v_pk_add_f32 v[102:103], v[102:103], v[150:151]
    v_cvt_pk_bf16_f32 v128, v88, v89
    v_cvt_pk_bf16_f32 v129, v90, v91
    v_cvt_pk_bf16_f32 v130, v92, v93
    v_cvt_pk_bf16_f32 v131, v94, v95
    v_cvt_pk_bf16_f32 v132, v96, v97
    v_cvt_pk_bf16_f32 v133, v98, v99
    v_cvt_pk_bf16_f32 v134, v100, v101
    v_cvt_pk_bf16_f32 v135, v102, v103
    ds_write_b128 v208, v[128:131] offset:32
    ds_write_b128 v208, v[132:135] offset:48
    v_pk_add_f32 v[104:105], v[104:105], v[152:153]
    v_pk_add_f32 v[106:107], v[106:107], v[154:155]
    v_pk_add_f32 v[108:109], v[108:109], v[156:157]
    v_pk_add_f32 v[110:111], v[110:111], v[158:159]
    v_pk_add_f32 v[112:113], v[112:113], v[160:161]
    v_pk_add_f32 v[114:115], v[114:115], v[162:163]
    v_pk_add_f32 v[116:117], v[116:117], v[164:165]
    v_pk_add_f32 v[118:119], v[118:119], v[166:167]
    v_cvt_pk_bf16_f32 v136, v104, v105
    v_cvt_pk_bf16_f32 v137, v106, v107
    v_cvt_pk_bf16_f32 v138, v108, v109
    v_cvt_pk_bf16_f32 v139, v110, v111
    v_cvt_pk_bf16_f32 v140, v112, v113
    v_cvt_pk_bf16_f32 v141, v114, v115
    v_cvt_pk_bf16_f32 v142, v116, v117
    v_cvt_pk_bf16_f32 v143, v118, v119
    ds_write_b128 v208, v[136:139] offset:64
    ds_write_b128 v208, v[140:143] offset:80
    s_waitcnt lgkmcnt(0)
    s_mov_b32 exec_hi, 0xfffffff
    ds_read_b128 v[168:171], v209 offset:0
    ds_read_b128 v[172:175], v209 offset:1040
    ds_read_b128 v[176:179], v209 offset:2944
    ds_read_b128 v[180:183], v209 offset:3984
    ds_read_b128 v[184:187], v209 offset:2080
    ds_read_b128 v[188:191], v209 offset:5024
    ds_read_b128 v[192:195], v209 offset:5888
    s_waitcnt lgkmcnt(6)
    buffer_store_dwordx4 v[168:171], v211, s[32:35], s72 offen offset:0 sc1 nt
    s_waitcnt lgkmcnt(5)
    buffer_store_dwordx4 v[172:175], v211, s[32:35], s72 offen offset:960 sc1 nt
    s_waitcnt lgkmcnt(4)
    buffer_store_dwordx4 v[176:179], v211, s[32:35], s73 offen offset:0 sc1 nt
    s_waitcnt lgkmcnt(3)
    buffer_store_dwordx4 v[180:183], v211, s[32:35], s73 offen offset:960 sc1 nt
    s_waitcnt lgkmcnt(2)
    s_mov_b32 exec_hi, 0xffff
    buffer_store_dwordx4 v[184:187], v211, s[32:35], s72 offen offset:1920 sc1 nt
    s_waitcnt lgkmcnt(1)
    buffer_store_dwordx4 v[188:191], v211, s[32:35], s73 offen offset:1920 sc1 nt
    s_waitcnt lgkmcnt(0)
    buffer_store_dwordx4 v[192:195], v210, s[32:35], s74 offen sc1 nt
L_bd:
    s_endpgm
L_A:
    s_waitcnt vmcnt(4)
    v_perm_b32 v176, v132, v128, s56
    v_perm_b32 v177, v140, v136, s56
    ds_write_b64 v12, v[176:177] offset:0
    v_perm_b32 v178, v132, v128, s57
    v_perm_b32 v179, v140, v136, s57
    ds_write_b64 v12, v[178:179] offset:96
    v_perm_b32 v180, v133, v129, s56
    v_perm_b32 v181, v141, v137, s56
    ds_write_b64 v12, v[180:181] offset:192
    v_perm_b32 v182, v133, v129, s57
    v_perm_b32 v183, v141, v137, s57
    ds_write_b64 v12, v[182:183] offset:288
    v_perm_b32 v184, v134, v130, s56
    v_perm_b32 v185, v142, v138, s56
    ds_write_b64 v12, v[184:185] offset:384
    v_perm_b32 v186, v134, v130, s57
    v_perm_b32 v187, v142, v138, s57
    ds_write_b64 v12, v[186:187] offset:480
    v_perm_b32 v188, v135, v131, s56
    v_perm_b32 v189, v143, v139, s56
    ds_write_b64 v12, v[188:189] offset:576
    v_perm_b32 v190, v135, v131, s57
    v_perm_b32 v191, v143, v139, s57
    ds_write_b64 v12, v[190:191] offset:672
    s_waitcnt vmcnt(0)
    v_perm_b32 v176, v148, v144, s56
    v_perm_b32 v177, v156, v152, s56
    ds_write_b64 v12, v[176:177] offset:18816
    v_perm_b32 v178, v148, v144, s57
    v_perm_b32 v179, v156, v152, s57
    ds_write_b64 v12, v[178:179] offset:18912
    v_perm_b32 v180, v149, v145, s56
    v_perm_b32 v181, v157, v153, s56
    ds_write_b64 v12, v[180:181] offset:19008
    v_perm_b32 v182, v149, v145, s57
    v_perm_b32 v183, v157, v153, s57
    ds_write_b64 v12, v[182:183] offset:19104
    v_perm_b32 v184, v150, v146, s56
    v_perm_b32 v185, v158, v154, s56
    ds_write_b64 v12, v[184:185] offset:19200
    v_perm_b32 v186, v150, v146, s57
    v_perm_b32 v187, v158, v154, s57
    ds_write_b64 v12, v[186:187] offset:19296
    v_perm_b32 v188, v151, v147, s56
    v_perm_b32 v189, v159, v155, s56
    ds_write_b64 v12, v[188:189] offset:19392
    v_perm_b32 v190, v151, v147, s57
    v_perm_b32 v191, v159, v155, s57
    ds_write_b64 v12, v[190:191] offset:19488
    s_waitcnt lgkmcnt(0)
    s_barrier
    ds_read_b128 v[32:35], v17 offset:0
    ds_read_b128 v[36:39], v17 offset:16
    ds_read_b128 v[20:23], v18 offset:0
    ds_read_b128 v[24:27], v18 offset:16
    ds_read_b64 v[28:29], v18 offset:32
    ds_read_b128 v[40:43], v17 offset:32
    ds_read_b128 v[44:47], v17 offset:48
    ds_read_b128 v[200:203], v18 offset:9408
    ds_read_b128 v[204:207], v18 offset:9424
    ds_read_b64 v[208:209], v18 offset:9440
    ds_read_b128 v[48:51], v17 offset:64
    ds_read_b128 v[52:55], v17 offset:80
    ds_read_b128 v[212:215], v18 offset:18816
    ds_read_b128 v[216:219], v18 offset:18832
    ds_read_b64 v[220:221], v18 offset:18848
    ds_read_b128 v[56:59], v17 offset:96
    ds_read_b128 v[60:63], v17 offset:112
    s_waitcnt lgkmcnt(14)
    v_swap_b32 v33, v36
    v_swap_b32 v35, v38
    s_nop 0
    v_mfma_f32_4x4x4_16b_bf16 v[64:67], v[32:33], v[20:21], 0
    s_nop 1
    v_mfma_f32_4x4x4_16b_bf16 v[64:67], v[36:37], v[22:23], v[64:67]
    v_mfma_f32_4x4x4_16b_bf16 v[92:95], v[32:33], v[22:23], 0
    s_waitcnt lgkmcnt(13)
    v_mfma_f32_4x4x4_16b_bf16 v[64:67], v[34:35], v[24:25], v[64:67]
    v_mfma_f32_4x4x4_16b_bf16 v[92:95], v[36:37], v[24:25], v[92:95]
    s_nop 0
    v_mfma_f32_4x4x4_16b_bf16 v[64:67], v[38:39], v[26:27], v[64:67]
    v_mfma_f32_4x4x4_16b_bf16 v[92:95], v[34:35], v[26:27], v[92:95]
    s_waitcnt lgkmcnt(12)
    s_nop 0
    v_mfma_f32_4x4x4_16b_bf16 v[92:95], v[38:39], v[28:29], v[92:95]
    ds_read_b128 v[20:23], v18 offset:28224
    ds_read_b128 v[24:27], v18 offset:28240
    ds_read_b64 v[28:29], v18 offset:28256
    s_waitcnt lgkmcnt(12)
    v_swap_b32 v41, v44
    v_swap_b32 v43, v46
    v_mfma_f32_4x4x4_16b_bf16 v[68:71], v[32:33], v[200:201], 0
    v_mfma_f32_4x4x4_16b_bf16 v[64:67], v[40:41], v[200:201], v[64:67]
    s_nop 1
    v_mfma_f32_4x4x4_16b_bf16 v[64:67], v[44:45], v[202:203], v[64:67]
    v_mfma_f32_4x4x4_16b_bf16 v[68:71], v[36:37], v[202:203], v[68:71]
    v_mfma_f32_4x4x4_16b_bf16 v[92:95], v[40:41], v[202:203], v[92:95]
    v_mfma_f32_4x4x4_16b_bf16 v[96:99], v[32:33], v[202:203], 0
    s_waitcnt lgkmcnt(11)
    v_mfma_f32_4x4x4_16b_bf16 v[64:67], v[42:43], v[204:205], v[64:67]
    v_mfma_f32_4x4x4_16b_bf16 v[68:71], v[34:35], v[204:205], v[68:71]
    v_mfma_f32_4x4x4_16b_bf16 v[92:95], v[44:45], v[204:205], v[92:95]
    v_mfma_f32_4x4x4_16b_bf16 v[96:99], v[36:37], v[204:205], v[96:99]
    v_mfma_f32_4x4x4_16b_bf16 v[64:67], v[46:47], v[206:207], v[64:67]
    v_mfma_f32_4x4x4_16b_bf16 v[68:71], v[38:39], v[206:207], v[68:71]
    v_mfma_f32_4x4x4_16b_bf16 v[92:95], v[42:43], v[206:207], v[92:95]
    v_mfma_f32_4x4x4_16b_bf16 v[96:99], v[34:35], v[206:207], v[96:99]
    s_waitcnt lgkmcnt(10)
    v_mfma_f32_4x4x4_16b_bf16 v[92:95], v[46:47], v[208:209], v[92:95]
    v_mfma_f32_4x4x4_16b_bf16 v[96:99], v[38:39], v[208:209], v[96:99]
    s_waitcnt lgkmcnt(7)
    v_swap_b32 v49, v52
    v_swap_b32 v51, v54
    v_mfma_f32_4x4x4_16b_bf16 v[72:75], v[32:33], v[212:213], 0
    v_mfma_f32_4x4x4_16b_bf16 v[68:71], v[40:41], v[212:213], v[68:71]
    v_mfma_f32_4x4x4_16b_bf16 v[64:67], v[48:49], v[212:213], v[64:67]
    s_nop 1
    v_mfma_f32_4x4x4_16b_bf16 v[64:67], v[52:53], v[214:215], v[64:67]
    v_mfma_f32_4x4x4_16b_bf16 v[68:71], v[44:45], v[214:215], v[68:71]
    v_mfma_f32_4x4x4_16b_bf16 v[72:75], v[36:37], v[214:215], v[72:75]
    v_mfma_f32_4x4x4_16b_bf16 v[92:95], v[48:49], v[214:215], v[92:95]
    v_mfma_f32_4x4x4_16b_bf16 v[96:99], v[40:41], v[214:215], v[96:99]
    v_mfma_f32_4x4x4_16b_bf16 v[100:103], v[32:33], v[214:215], 0
    s_waitcnt lgkmcnt(6)
    v_mfma_f32_4x4x4_16b_bf16 v[64:67], v[50:51], v[216:217], v[64:67]
    v_mfma_f32_4x4x4_16b_bf16 v[68:71], v[42:43], v[216:217], v[68:71]
    v_mfma_f32_4x4x4_16b_bf16 v[72:75], v[34:35], v[216:217], v[72:75]
    v_mfma_f32_4x4x4_16b_bf16 v[92:95], v[52:53], v[216:217], v[92:95]
    v_mfma_f32_4x4x4_16b_bf16 v[96:99], v[44:45], v[216:217], v[96:99]
    v_mfma_f32_4x4x4_16b_bf16 v[100:103], v[36:37], v[216:217], v[100:103]
    v_mfma_f32_4x4x4_16b_bf16 v[64:67], v[54:55], v[218:219], v[64:67]
    v_mfma_f32_4x4x4_16b_bf16 v[68:71], v[46:47], v[218:219], v[68:71]
    v_mfma_f32_4x4x4_16b_bf16 v[72:75], v[38:39], v[218:219], v[72:75]
    v_mfma_f32_4x4x4_16b_bf16 v[92:95], v[50:51], v[218:219], v[92:95]
    v_mfma_f32_4x4x4_16b_bf16 v[96:99], v[42:43], v[218:219], v[96:99]
    v_mfma_f32_4x4x4_16b_bf16 v[100:103], v[34:35], v[218:219], v[100:103]
    s_waitcnt lgkmcnt(5)
    v_mfma_f32_4x4x4_16b_bf16 v[92:95], v[54:55], v[220:221], v[92:95]
    v_mfma_f32_4x4x4_16b_bf16 v[96:99], v[46:47], v[220:221], v[96:99]
    v_mfma_f32_4x4x4_16b_bf16 v[100:103], v[38:39], v[220:221], v[100:103]
    s_waitcnt lgkmcnt(2)
    v_swap_b32 v57, v60
    v_swap_b32 v59, v62
    v_mfma_f32_4x4x4_16b_bf16 v[76:79], v[32:33], v[20:21], 0
    v_mfma_f32_4x4x4_16b_bf16 v[72:75], v[40:41], v[20:21], v[72:75]
    v_mfma_f32_4x4x4_16b_bf16 v[68:71], v[48:49], v[20:21], v[68:71]
    v_mfma_f32_4x4x4_16b_bf16 v[64:67], v[56:57], v[20:21], v[64:67]
    s_nop 1
    v_mfma_f32_4x4x4_16b_bf16 v[64:67], v[60:61], v[22:23], v[64:67]
    v_mfma_f32_4x4x4_16b_bf16 v[68:71], v[52:53], v[22:23], v[68:71]
    v_mfma_f32_4x4x4_16b_bf16 v[72:75], v[44:45], v[22:23], v[72:75]
    v_mfma_f32_4x4x4_16b_bf16 v[76:79], v[36:37], v[22:23], v[76:79]
    v_mfma_f32_4x4x4_16b_bf16 v[92:95], v[56:57], v[22:23], v[92:95]
    v_mfma_f32_4x4x4_16b_bf16 v[96:99], v[48:49], v[22:23], v[96:99]
    v_mfma_f32_4x4x4_16b_bf16 v[100:103], v[40:41], v[22:23], v[100:103]
    v_mfma_f32_4x4x4_16b_bf16 v[104:107], v[32:33], v[22:23], 0
    s_waitcnt lgkmcnt(1)
    v_mfma_f32_4x4x4_16b_bf16 v[64:67], v[58:59], v[24:25], v[64:67]
    v_mfma_f32_4x4x4_16b_bf16 v[68:71], v[50:51], v[24:25], v[68:71]
    v_mfma_f32_4x4x4_16b_bf16 v[72:75], v[42:43], v[24:25], v[72:75]
    v_mfma_f32_4x4x4_16b_bf16 v[76:79], v[34:35], v[24:25], v[76:79]
    v_mfma_f32_4x4x4_16b_bf16 v[92:95], v[60:61], v[24:25], v[92:95]
    v_mfma_f32_4x4x4_16b_bf16 v[96:99], v[52:53], v[24:25], v[96:99]
    v_mfma_f32_4x4x4_16b_bf16 v[100:103], v[44:45], v[24:25], v[100:103]
    v_mfma_f32_4x4x4_16b_bf16 v[104:107], v[36:37], v[24:25], v[104:107]
    v_mfma_f32_4x4x4_16b_bf16 v[64:67], v[62:63], v[26:27], v[64:67]
    v_mfma_f32_4x4x4_16b_bf16 v[68:71], v[54:55], v[26:27], v[68:71]
    v_mfma_f32_4x4x4_16b_bf16 v[72:75], v[46:47], v[26:27], v[72:75]
    v_mfma_f32_4x4x4_16b_bf16 v[76:79], v[38:39], v[26:27], v[76:79]
    v_mfma_f32_4x4x4_16b_bf16 v[92:95], v[58:59], v[26:27], v[92:95]
    v_mfma_f32_4x4x4_16b_bf16 v[96:99], v[50:51], v[26:27], v[96:99]
    v_mfma_f32_4x4x4_16b_bf16 v[100:103], v[42:43], v[26:27], v[100:103]
    v_mfma_f32_4x4x4_16b_bf16 v[104:107], v[34:35], v[26:27], v[104:107]
    s_waitcnt lgkmcnt(0)
    v_mfma_f32_4x4x4_16b_bf16 v[92:95], v[62:63], v[28:29], v[92:95]
    v_mfma_f32_4x4x4_16b_bf16 v[96:99], v[54:55], v[28:29], v[96:99]
    v_mfma_f32_4x4x4_16b_bf16 v[100:103], v[46:47], v[28:29], v[100:103]
    v_mfma_f32_4x4x4_16b_bf16 v[104:107], v[38:39], v[28:29], v[104:107]
    v_cvt_pk_bf16_f32 v192, v64, v65
    v_cvt_pk_bf16_f32 v193, v66, v67
    v_cvt_pk_bf16_f32 v194, v92, v93
    v_cvt_pk_bf16_f32 v195, v94, v95
    ds_write_b128 v15, v[192:195] offset:0
    s_waitcnt lgkmcnt(0)
    s_barrier
    ds_read_b128 v[200:203], v18 offset:37632
    ds_read_b128 v[204:207], v18 offset:37648
    ds_read_b64 v[208:209], v18 offset:37664
    ds_read_b128 v[212:215], v19 offset:0
    ds_read_b128 v[216:219], v19 offset:16
    ds_read_b64 v[220:221], v19 offset:32
    s_waitcnt lgkmcnt(5)
    v_mfma_f32_4x4x4_16b_bf16 v[68:71], v[56:57], v[200:201], v[68:71]
    v_mfma_f32_4x4x4_16b_bf16 v[72:75], v[48:49], v[200:201], v[72:75]
    v_mfma_f32_4x4x4_16b_bf16 v[76:79], v[40:41], v[200:201], v[76:79]
    v_mfma_f32_4x4x4_16b_bf16 v[80:83], v[32:33], v[200:201], 0
    v_mfma_f32_4x4x4_16b_bf16 v[68:71], v[60:61], v[202:203], v[68:71]
    v_mfma_f32_4x4x4_16b_bf16 v[72:75], v[52:53], v[202:203], v[72:75]
    v_mfma_f32_4x4x4_16b_bf16 v[76:79], v[44:45], v[202:203], v[76:79]
    v_mfma_f32_4x4x4_16b_bf16 v[80:83], v[36:37], v[202:203], v[80:83]
    v_mfma_f32_4x4x4_16b_bf16 v[96:99], v[56:57], v[202:203], v[96:99]
    v_mfma_f32_4x4x4_16b_bf16 v[100:103], v[48:49], v[202:203], v[100:103]
    v_mfma_f32_4x4x4_16b_bf16 v[104:107], v[40:41], v[202:203], v[104:107]
    v_mfma_f32_4x4x4_16b_bf16 v[108:111], v[32:33], v[202:203], 0
    s_waitcnt lgkmcnt(4)
    v_mfma_f32_4x4x4_16b_bf16 v[68:71], v[58:59], v[204:205], v[68:71]
    v_mfma_f32_4x4x4_16b_bf16 v[72:75], v[50:51], v[204:205], v[72:75]
    v_mfma_f32_4x4x4_16b_bf16 v[76:79], v[42:43], v[204:205], v[76:79]
    v_mfma_f32_4x4x4_16b_bf16 v[80:83], v[34:35], v[204:205], v[80:83]
    v_mfma_f32_4x4x4_16b_bf16 v[96:99], v[60:61], v[204:205], v[96:99]
    v_mfma_f32_4x4x4_16b_bf16 v[100:103], v[52:53], v[204:205], v[100:103]
    v_mfma_f32_4x4x4_16b_bf16 v[104:107], v[44:45], v[204:205], v[104:107]
    v_mfma_f32_4x4x4_16b_bf16 v[108:111], v[36:37], v[204:205], v[108:111]
    v_mfma_f32_4x4x4_16b_bf16 v[68:71], v[62:63], v[206:207], v[68:71]
    v_mfma_f32_4x4x4_16b_bf16 v[72:75], v[54:55], v[206:207], v[72:75]
    v_mfma_f32_4x4x4_16b_bf16 v[76:79], v[46:47], v[206:207], v[76:79]
    v_mfma_f32_4x4x4_16b_bf16 v[80:83], v[38:39], v[206:207], v[80:83]
    v_mfma_f32_4x4x4_16b_bf16 v[96:99], v[58:59], v[206:207], v[96:99]
    v_mfma_f32_4x4x4_16b_bf16 v[100:103], v[50:51], v[206:207], v[100:103]
    v_mfma_f32_4x4x4_16b_bf16 v[104:107], v[42:43], v[206:207], v[104:107]
    v_mfma_f32_4x4x4_16b_bf16 v[108:111], v[34:35], v[206:207], v[108:111]
    s_waitcnt lgkmcnt(3)
    v_mfma_f32_4x4x4_16b_bf16 v[96:99], v[62:63], v[208:209], v[96:99]
    v_mfma_f32_4x4x4_16b_bf16 v[100:103], v[54:55], v[208:209], v[100:103]
    v_mfma_f32_4x4x4_16b_bf16 v[104:107], v[46:47], v[208:209], v[104:107]
    v_mfma_f32_4x4x4_16b_bf16 v[108:111], v[38:39], v[208:209], v[108:111]
    s_waitcnt lgkmcnt(2)
    v_mfma_f32_4x4x4_16b_bf16 v[72:75], v[56:57], v[212:213], v[72:75]
    v_mfma_f32_4x4x4_16b_bf16 v[76:79], v[48:49], v[212:213], v[76:79]
    v_cvt_pk_bf16_f32 v196, v68, v69
    v_cvt_pk_bf16_f32 v197, v70, v71
    v_cvt_pk_bf16_f32 v198, v96, v97
    v_cvt_pk_bf16_f32 v199, v98, v99
    ds_write_b128 v15, v[196:199] offset:64
    v_mfma_f32_4x4x4_16b_bf16 v[80:83], v[40:41], v[212:213], v[80:83]
    v_mfma_f32_4x4x4_16b_bf16 v[84:87], v[32:33], v[212:213], 0
    v_mfma_f32_4x4x4_16b_bf16 v[72:75], v[60:61], v[214:215], v[72:75]
    v_mfma_f32_4x4x4_16b_bf16 v[76:79], v[52:53], v[214:215], v[76:79]
    v_mfma_f32_4x4x4_16b_bf16 v[80:83], v[44:45], v[214:215], v[80:83]
    v_mfma_f32_4x4x4_16b_bf16 v[84:87], v[36:37], v[214:215], v[84:87]
    v_mfma_f32_4x4x4_16b_bf16 v[100:103], v[56:57], v[214:215], v[100:103]
    v_mfma_f32_4x4x4_16b_bf16 v[104:107], v[48:49], v[214:215], v[104:107]
    v_mfma_f32_4x4x4_16b_bf16 v[108:111], v[40:41], v[214:215], v[108:111]
    v_mfma_f32_4x4x4_16b_bf16 v[112:115], v[32:33], v[214:215], 0
    s_waitcnt lgkmcnt(2)
    v_mfma_f32_4x4x4_16b_bf16 v[72:75], v[58:59], v[216:217], v[72:75]
    v_mfma_f32_4x4x4_16b_bf16 v[76:79], v[50:51], v[216:217], v[76:79]
    v_mfma_f32_4x4x4_16b_bf16 v[80:83], v[42:43], v[216:217], v[80:83]
    v_mfma_f32_4x4x4_16b_bf16 v[84:87], v[34:35], v[216:217], v[84:87]
    v_mfma_f32_4x4x4_16b_bf16 v[100:103], v[60:61], v[216:217], v[100:103]
    v_mfma_f32_4x4x4_16b_bf16 v[104:107], v[52:53], v[216:217], v[104:107]
    v_mfma_f32_4x4x4_16b_bf16 v[108:111], v[44:45], v[216:217], v[108:111]
    v_mfma_f32_4x4x4_16b_bf16 v[112:115], v[36:37], v[216:217], v[112:115]
    v_mfma_f32_4x4x4_16b_bf16 v[72:75], v[62:63], v[218:219], v[72:75]
    v_mfma_f32_4x4x4_16b_bf16 v[76:79], v[54:55], v[218:219], v[76:79]
    v_mfma_f32_4x4x4_16b_bf16 v[80:83], v[46:47], v[218:219], v[80:83]
    v_mfma_f32_4x4x4_16b_bf16 v[84:87], v[38:39], v[218:219], v[84:87]
    v_mfma_f32_4x4x4_16b_bf16 v[100:103], v[58:59], v[218:219], v[100:103]
    v_mfma_f32_4x4x4_16b_bf16 v[104:107], v[50:51], v[218:219], v[104:107]
    v_mfma_f32_4x4x4_16b_bf16 v[108:111], v[42:43], v[218:219], v[108:111]
    v_mfma_f32_4x4x4_16b_bf16 v[112:115], v[34:35], v[218:219], v[112:115]
    s_waitcnt lgkmcnt(1)
    v_mfma_f32_4x4x4_16b_bf16 v[100:103], v[62:63], v[220:221], v[100:103]
    v_mfma_f32_4x4x4_16b_bf16 v[104:107], v[54:55], v[220:221], v[104:107]
    v_mfma_f32_4x4x4_16b_bf16 v[108:111], v[46:47], v[220:221], v[108:111]
    v_mfma_f32_4x4x4_16b_bf16 v[112:115], v[38:39], v[220:221], v[112:115]
    v_cvt_pk_bf16_f32 v192, v72, v73
    v_cvt_pk_bf16_f32 v193, v74, v75
    v_cvt_pk_bf16_f32 v194, v100, v101
    v_cvt_pk_bf16_f32 v195, v102, v103
    ds_write_b128 v15, v[192:195] offset:128
    s_waitcnt lgkmcnt(0)
    s_barrier
    ds_read_b128 v[20:23], v19 offset:9408
    ds_read_b128 v[24:27], v19 offset:9424
    ds_read_b64 v[28:29], v19 offset:9440
    ds_read_b128 v[200:203], v19 offset:18816
    ds_read_b128 v[204:207], v19 offset:18832
    ds_read_b64 v[208:209], v19 offset:18848
    ds_read_b128 v[212:215], v19 offset:28224
    ds_read_b128 v[216:219], v19 offset:28240
    ds_read_b64 v[220:221], v19 offset:28256
    s_waitcnt lgkmcnt(8)
    v_mfma_f32_4x4x4_16b_bf16 v[76:79], v[56:57], v[20:21], v[76:79]
    v_mfma_f32_4x4x4_16b_bf16 v[80:83], v[48:49], v[20:21], v[80:83]
    v_mfma_f32_4x4x4_16b_bf16 v[84:87], v[40:41], v[20:21], v[84:87]
    v_mfma_f32_4x4x4_16b_bf16 v[88:91], v[32:33], v[20:21], 0
    v_mfma_f32_4x4x4_16b_bf16 v[76:79], v[60:61], v[22:23], v[76:79]
    v_mfma_f32_4x4x4_16b_bf16 v[80:83], v[52:53], v[22:23], v[80:83]
    v_mfma_f32_4x4x4_16b_bf16 v[84:87], v[44:45], v[22:23], v[84:87]
    v_mfma_f32_4x4x4_16b_bf16 v[88:91], v[36:37], v[22:23], v[88:91]
    v_mfma_f32_4x4x4_16b_bf16 v[104:107], v[56:57], v[22:23], v[104:107]
    v_mfma_f32_4x4x4_16b_bf16 v[108:111], v[48:49], v[22:23], v[108:111]
    v_mfma_f32_4x4x4_16b_bf16 v[112:115], v[40:41], v[22:23], v[112:115]
    v_mfma_f32_4x4x4_16b_bf16 v[116:119], v[32:33], v[22:23], 0
    s_waitcnt lgkmcnt(7)
    v_mfma_f32_4x4x4_16b_bf16 v[76:79], v[58:59], v[24:25], v[76:79]
    v_mfma_f32_4x4x4_16b_bf16 v[80:83], v[50:51], v[24:25], v[80:83]
    v_mfma_f32_4x4x4_16b_bf16 v[84:87], v[42:43], v[24:25], v[84:87]
    v_mfma_f32_4x4x4_16b_bf16 v[88:91], v[34:35], v[24:25], v[88:91]
    v_mfma_f32_4x4x4_16b_bf16 v[104:107], v[60:61], v[24:25], v[104:107]
    v_mfma_f32_4x4x4_16b_bf16 v[108:111], v[52:53], v[24:25], v[108:111]
    v_mfma_f32_4x4x4_16b_bf16 v[112:115], v[44:45], v[24:25], v[112:115]
    v_mfma_f32_4x4x4_16b_bf16 v[116:119], v[36:37], v[24:25], v[116:119]
    v_mfma_f32_4x4x4_16b_bf16 v[76:79], v[62:63], v[26:27], v[76:79]
    v_mfma_f32_4x4x4_16b_bf16 v[80:83], v[54:55], v[26:27], v[80:83]
    v_mfma_f32_4x4x4_16b_bf16 v[84:87], v[46:47], v[26:27], v[84:87]
    v_mfma_f32_4x4x4_16b_bf16 v[88:91], v[38:39], v[26:27], v[88:91]
    v_mfma_f32_4x4x4_16b_bf16 v[104:107], v[58:59], v[26:27], v[104:107]
    v_mfma_f32_4x4x4_16b_bf16 v[108:111], v[50:51], v[26:27], v[108:111]
    v_mfma_f32_4x4x4_16b_bf16 v[112:115], v[42:43], v[26:27], v[112:115]
    v_mfma_f32_4x4x4_16b_bf16 v[116:119], v[34:35], v[26:27], v[116:119]
    s_waitcnt lgkmcnt(6)
    v_mfma_f32_4x4x4_16b_bf16 v[104:107], v[62:63], v[28:29], v[104:107]
    v_mfma_f32_4x4x4_16b_bf16 v[108:111], v[54:55], v[28:29], v[108:111]
    v_mfma_f32_4x4x4_16b_bf16 v[112:115], v[46:47], v[28:29], v[112:115]
    v_mfma_f32_4x4x4_16b_bf16 v[116:119], v[38:39], v[28:29], v[116:119]
    ds_read_b128 v[20:23], v19 offset:37632
    ds_read_b128 v[24:27], v19 offset:37648
    ds_read_b64 v[28:29], v19 offset:37664
    s_waitcnt lgkmcnt(8)
    v_mfma_f32_4x4x4_16b_bf16 v[80:83], v[56:57], v[200:201], v[80:83]
    v_mfma_f32_4x4x4_16b_bf16 v[84:87], v[48:49], v[200:201], v[84:87]
    v_cvt_pk_bf16_f32 v196, v76, v77
    v_cvt_pk_bf16_f32 v197, v78, v79
    v_cvt_pk_bf16_f32 v198, v104, v105
    v_cvt_pk_bf16_f32 v199, v106, v107
    ds_write_b128 v15, v[196:199] offset:192
    v_mfma_f32_4x4x4_16b_bf16 v[88:91], v[40:41], v[200:201], v[88:91]
    v_mfma_f32_4x4x4_16b_bf16 v[80:83], v[60:61], v[202:203], v[80:83]
    v_mfma_f32_4x4x4_16b_bf16 v[84:87], v[52:53], v[202:203], v[84:87]
    v_mfma_f32_4x4x4_16b_bf16 v[88:91], v[44:45], v[202:203], v[88:91]
    v_mfma_f32_4x4x4_16b_bf16 v[108:111], v[56:57], v[202:203], v[108:111]
    v_mfma_f32_4x4x4_16b_bf16 v[112:115], v[48:49], v[202:203], v[112:115]
    v_mfma_f32_4x4x4_16b_bf16 v[116:119], v[40:41], v[202:203], v[116:119]
    s_waitcnt lgkmcnt(8)
    v_mfma_f32_4x4x4_16b_bf16 v[80:83], v[58:59], v[204:205], v[80:83]
    v_mfma_f32_4x4x4_16b_bf16 v[84:87], v[50:51], v[204:205], v[84:87]
    v_mfma_f32_4x4x4_16b_bf16 v[88:91], v[42:43], v[204:205], v[88:91]
    v_mfma_f32_4x4x4_16b_bf16 v[108:111], v[60:61], v[204:205], v[108:111]
    v_mfma_f32_4x4x4_16b_bf16 v[112:115], v[52:53], v[204:205], v[112:115]
    v_mfma_f32_4x4x4_16b_bf16 v[116:119], v[44:45], v[204:205], v[116:119]
    v_mfma_f32_4x4x4_16b_bf16 v[80:83], v[62:63], v[206:207], v[80:83]
    v_mfma_f32_4x4x4_16b_bf16 v[84:87], v[54:55], v[206:207], v[84:87]
    v_mfma_f32_4x4x4_16b_bf16 v[88:91], v[46:47], v[206:207], v[88:91]
    v_mfma_f32_4x4x4_16b_bf16 v[108:111], v[58:59], v[206:207], v[108:111]
    v_mfma_f32_4x4x4_16b_bf16 v[112:115], v[50:51], v[206:207], v[112:115]
    v_mfma_f32_4x4x4_16b_bf16 v[116:119], v[42:43], v[206:207], v[116:119]
    s_waitcnt lgkmcnt(7)
    v_mfma_f32_4x4x4_16b_bf16 v[108:111], v[62:63], v[208:209], v[108:111]
    v_mfma_f32_4x4x4_16b_bf16 v[112:115], v[54:55], v[208:209], v[112:115]
    v_mfma_f32_4x4x4_16b_bf16 v[116:119], v[46:47], v[208:209], v[116:119]
    s_waitcnt lgkmcnt(6)
    v_mfma_f32_4x4x4_16b_bf16 v[84:87], v[56:57], v[212:213], v[84:87]
    v_mfma_f32_4x4x4_16b_bf16 v[88:91], v[48:49], v[212:213], v[88:91]
    s_nop 0
    v_mfma_f32_4x4x4_16b_bf16 v[84:87], v[60:61], v[214:215], v[84:87]
    v_cvt_pk_bf16_f32 v192, v80, v81
    v_cvt_pk_bf16_f32 v193, v82, v83
    v_cvt_pk_bf16_f32 v194, v108, v109
    v_cvt_pk_bf16_f32 v195, v110, v111
    ds_write_b128 v15, v[192:195] offset:256
    v_mfma_f32_4x4x4_16b_bf16 v[88:91], v[52:53], v[214:215], v[88:91]
    v_mfma_f32_4x4x4_16b_bf16 v[112:115], v[56:57], v[214:215], v[112:115]
    v_mfma_f32_4x4x4_16b_bf16 v[116:119], v[48:49], v[214:215], v[116:119]
    s_waitcnt lgkmcnt(6)
    v_mfma_f32_4x4x4_16b_bf16 v[84:87], v[58:59], v[216:217], v[84:87]
    v_mfma_f32_4x4x4_16b_bf16 v[88:91], v[50:51], v[216:217], v[88:91]
    v_mfma_f32_4x4x4_16b_bf16 v[112:115], v[60:61], v[216:217], v[112:115]
    v_mfma_f32_4x4x4_16b_bf16 v[116:119], v[52:53], v[216:217], v[116:119]
    v_mfma_f32_4x4x4_16b_bf16 v[84:87], v[62:63], v[218:219], v[84:87]
    v_mfma_f32_4x4x4_16b_bf16 v[88:91], v[54:55], v[218:219], v[88:91]
    v_mfma_f32_4x4x4_16b_bf16 v[112:115], v[58:59], v[218:219], v[112:115]
    v_mfma_f32_4x4x4_16b_bf16 v[116:119], v[50:51], v[218:219], v[116:119]
    s_waitcnt lgkmcnt(5)
    v_mfma_f32_4x4x4_16b_bf16 v[112:115], v[62:63], v[220:221], v[112:115]
    v_mfma_f32_4x4x4_16b_bf16 v[116:119], v[54:55], v[220:221], v[116:119]
    s_waitcnt lgkmcnt(4)
    v_mfma_f32_4x4x4_16b_bf16 v[88:91], v[56:57], v[20:21], v[88:91]
    s_nop 1
    v_mfma_f32_4x4x4_16b_bf16 v[88:91], v[60:61], v[22:23], v[88:91]
    v_mfma_f32_4x4x4_16b_bf16 v[116:119], v[56:57], v[22:23], v[116:119]
    s_waitcnt lgkmcnt(3)
    v_mfma_f32_4x4x4_16b_bf16 v[88:91], v[58:59], v[24:25], v[88:91]
    v_cvt_pk_bf16_f32 v196, v84, v85
    v_cvt_pk_bf16_f32 v197, v86, v87
    v_cvt_pk_bf16_f32 v198, v112, v113
    v_cvt_pk_bf16_f32 v199, v114, v115
    ds_write_b128 v15, v[196:199] offset:320
    v_mfma_f32_4x4x4_16b_bf16 v[116:119], v[60:61], v[24:25], v[116:119]
    v_mfma_f32_4x4x4_16b_bf16 v[88:91], v[62:63], v[26:27], v[88:91]
    s_nop 0
    v_mfma_f32_4x4x4_16b_bf16 v[116:119], v[58:59], v[26:27], v[116:119]
    s_waitcnt lgkmcnt(3)
    s_nop 0
    v_mfma_f32_4x4x4_16b_bf16 v[116:119], v[62:63], v[28:29], v[116:119]
    v_cvt_pk_bf16_f32 v192, v88, v89
    v_cvt_pk_bf16_f32 v193, v90, v91
    s_nop 2
    v_cvt_pk_bf16_f32 v194, v116, v117
    v_cvt_pk_bf16_f32 v195, v118, v119
    ds_write_b64 v16, v[192:193]
    s_mov_b64 exec, s[70:71]
    ds_write_b64 v16, v[194:195] offset:64
    s_mov_b64 exec, -1
    s_waitcnt lgkmcnt(0)
    s_barrier
    s_setprio 2
    ds_read_b64_tr_b16 v[0:1], v231 offset:0
    ds_read_b64_tr_b16 v[2:3], v231 offset:3584
    ds_read_b64_tr_b16 v[4:5], v231 offset:7168
    ds_read_b64_tr_b16 v[6:7], v231 offset:10752
    ds_read_b64_tr_b16 v[8:9], v231 offset:14336
    ds_read_b64_tr_b16 v[10:11], v231 offset:17920
    ds_read_b64_tr_b16 v[12:13], v231 offset:21504
    ds_read_b64_tr_b16 v[14:15], v231 offset:25088
    ds_read_b64_tr_b16 v[16:17], v231 offset:28672
    ds_read_b64_tr_b16 v[18:19], v231 offset:32256
    ds_read_b64_tr_b16 v[20:21], v231 offset:35840
    ds_read_b64_tr_b16 v[22:23], v231 offset:39424
    v_mov_b32 v88, 0x3f803f80
    v_mov_b32 v89, 0x3f803f80
    v_mov_b32 v90, 0x3f803f80
    v_mov_b32 v91, 0x3f803f80
    s_waitcnt lgkmcnt(0)
    ds_read_b64_tr_b16 v[24:25], v228 offset:0
    ds_read_b64_tr_b16 v[26:27], v228 offset:512
    ds_read_b64_tr_b16 v[28:29], v228 offset:1024
    ds_read_b64_tr_b16 v[30:31], v228 offset:1536
    ds_read_b64_tr_b16 v[32:33], v228 offset:2048
    ds_read_b64_tr_b16 v[34:35], v228 offset:2560
    ds_read_b64_tr_b16 v[36:37], v228 offset:3072
    ds_read_b64_tr_b16 v[38:39], v228 offset:3584
    ds_read_b64_tr_b16 v[40:41], v228 offset:4096
    ds_read_b64_tr_b16 v[42:43], v228 offset:4608
    ds_read_b64_tr_b16 v[44:45], v228 offset:5120
    ds_read_b64_tr_b16 v[46:47], v228 offset:5632
    v_mfma_f32_32x32x16_bf16 v[72:87], v[88:91], v[0:3], 0
    v_lshlrev_b32 v120, 16, v0
    v_and_b32 v121, 0xffff0000, v0
    v_lshlrev_b32 v122, 16, v1
    v_and_b32 v123, 0xffff0000, v1
    v_lshlrev_b32 v124, 16, v2
    v_and_b32 v125, 0xffff0000, v2
    v_lshlrev_b32 v126, 16, v3
    v_and_b32 v127, 0xffff0000, v3
    v_mfma_f32_32x32x16_bf16 v[72:87], v[88:91], v[4:7], v[72:87]
    v_lshlrev_b32 v128, 16, v4
    v_and_b32 v129, 0xffff0000, v4
    v_lshlrev_b32 v130, 16, v5
    v_and_b32 v131, 0xffff0000, v5
    v_lshlrev_b32 v132, 16, v6
    v_and_b32 v133, 0xffff0000, v6
    v_lshlrev_b32 v134, 16, v7
    v_and_b32 v135, 0xffff0000, v7
    v_mfma_f32_32x32x16_bf16 v[72:87], v[88:91], v[8:11], v[72:87]
    v_lshlrev_b32 v136, 16, v8
    v_and_b32 v137, 0xffff0000, v8
    v_lshlrev_b32 v138, 16, v9
    v_and_b32 v139, 0xffff0000, v9
    v_lshlrev_b32 v140, 16, v10
    v_and_b32 v141, 0xffff0000, v10
    v_lshlrev_b32 v142, 16, v11
    v_and_b32 v143, 0xffff0000, v11
    v_mfma_f32_32x32x16_bf16 v[72:87], v[88:91], v[12:15], v[72:87]
    v_lshlrev_b32 v144, 16, v12
    v_and_b32 v145, 0xffff0000, v12
    v_lshlrev_b32 v146, 16, v13
    v_and_b32 v147, 0xffff0000, v13
    v_lshlrev_b32 v148, 16, v14
    v_and_b32 v149, 0xffff0000, v14
    v_lshlrev_b32 v150, 16, v15
    v_and_b32 v151, 0xffff0000, v15
    v_mfma_f32_32x32x16_bf16 v[72:87], v[88:91], v[16:19], v[72:87]
    v_lshlrev_b32 v152, 16, v16
    v_and_b32 v153, 0xffff0000, v16
    v_lshlrev_b32 v154, 16, v17
    v_and_b32 v155, 0xffff0000, v17
    v_lshlrev_b32 v156, 16, v18
    v_and_b32 v157, 0xffff0000, v18
    v_lshlrev_b32 v158, 16, v19
    v_and_b32 v159, 0xffff0000, v19
    v_mfma_f32_32x32x16_bf16 v[72:87], v[88:91], v[20:23], v[72:87]
    v_lshlrev_b32 v160, 16, v20
    v_and_b32 v161, 0xffff0000, v20
    v_lshlrev_b32 v162, 16, v21
    v_and_b32 v163, 0xffff0000, v21
    v_lshlrev_b32 v164, 16, v22
    v_and_b32 v165, 0xffff0000, v22
    v_lshlrev_b32 v166, 16, v23
    v_and_b32 v167, 0xffff0000, v23
    v_pk_mul_f32 v[118:119], v[120:121], v[120:121]
    v_pk_mul_f32 v[116:117], v[122:123], v[122:123]
    v_pk_fma_f32 v[118:119], v[124:125], v[124:125], v[118:119]
    v_pk_fma_f32 v[116:117], v[126:127], v[126:127], v[116:117]
    v_pk_fma_f32 v[118:119], v[128:129], v[128:129], v[118:119]
    v_pk_fma_f32 v[116:117], v[130:131], v[130:131], v[116:117]
    v_pk_fma_f32 v[118:119], v[132:133], v[132:133], v[118:119]
    v_pk_fma_f32 v[116:117], v[134:135], v[134:135], v[116:117]
    v_pk_fma_f32 v[118:119], v[136:137], v[136:137], v[118:119]
    v_pk_fma_f32 v[116:117], v[138:139], v[138:139], v[116:117]
    v_pk_fma_f32 v[118:119], v[140:141], v[140:141], v[118:119]
    v_pk_fma_f32 v[116:117], v[142:143], v[142:143], v[116:117]
    v_pk_fma_f32 v[118:119], v[144:145], v[144:145], v[118:119]
    v_pk_fma_f32 v[116:117], v[146:147], v[146:147], v[116:117]
    v_pk_fma_f32 v[118:119], v[148:149], v[148:149], v[118:119]
    v_pk_fma_f32 v[116:117], v[150:151], v[150:151], v[116:117]
    v_pk_fma_f32 v[118:119], v[152:153], v[152:153], v[118:119]
    v_pk_fma_f32 v[116:117], v[154:155], v[154:155], v[116:117]
    v_pk_fma_f32 v[118:119], v[156:157], v[156:157], v[118:119]
    v_pk_fma_f32 v[116:117], v[158:159], v[158:159], v[116:117]
    v_pk_fma_f32 v[118:119], v[160:161], v[160:161], v[118:119]
    v_pk_fma_f32 v[116:117], v[162:163], v[162:163], v[116:117]
    v_pk_fma_f32 v[118:119], v[164:165], v[164:165], v[118:119]
    v_pk_fma_f32 v[116:117], v[166:167], v[166:167], v[116:117]
    v_pk_add_f32 v[118:119], v[118:119], v[116:117]
    v_mov_b32 v116, v72
    v_add_f32 v118, v118, v119
    v_add_f32 v119, v118, 0
    s_nop 1
    v_permlane32_swap_b32 v118, v119
    v_add_f32 v118, v118, v119
    v_mul_f32 v116, 0x3c2aaaab, v116
    v_mul_f32 v118, 0x3c2aaaab, v118
    v_fma_f32 v118, -v116, v116, v118
    v_max_f32 v118, 0, v118
    v_add_f32 v118, 0x3727c5ac, v118
    v_rsq_f32 v118, v118
    s_nop 0
    v_mul_f32 v118, 0x3eeff558, v118
    v_mul_f32 v119, v116, v118
    v_sub_f32 v119, 0, v119
    v_pk_fma_f32 v[120:121], v[120:121], v[118:119], v[118:119] op_sel:[0,0,1] op_sel_hi:[1,0,1]
    v_pk_fma_f32 v[122:123], v[122:123], v[118:119], v[118:119] op_sel:[0,0,1] op_sel_hi:[1,0,1]
    v_pk_fma_f32 v[124:125], v[124:125], v[118:119], v[118:119] op_sel:[0,0,1] op_sel_hi:[1,0,1]
    v_pk_fma_f32 v[126:127], v[126:127], v[118:119], v[118:119] op_sel:[0,0,1] op_sel_hi:[1,0,1]
    v_pk_fma_f32 v[128:129], v[128:129], v[118:119], v[118:119] op_sel:[0,0,1] op_sel_hi:[1,0,1]
    v_pk_fma_f32 v[130:131], v[130:131], v[118:119], v[118:119] op_sel:[0,0,1] op_sel_hi:[1,0,1]
    v_pk_fma_f32 v[132:133], v[132:133], v[118:119], v[118:119] op_sel:[0,0,1] op_sel_hi:[1,0,1]
    v_pk_fma_f32 v[134:135], v[134:135], v[118:119], v[118:119] op_sel:[0,0,1] op_sel_hi:[1,0,1]
    v_pk_fma_f32 v[136:137], v[136:137], v[118:119], v[118:119] op_sel:[0,0,1] op_sel_hi:[1,0,1]
    v_pk_fma_f32 v[138:139], v[138:139], v[118:119], v[118:119] op_sel:[0,0,1] op_sel_hi:[1,0,1]
    v_pk_fma_f32 v[140:141], v[140:141], v[118:119], v[118:119] op_sel:[0,0,1] op_sel_hi:[1,0,1]
    v_pk_fma_f32 v[142:143], v[142:143], v[118:119], v[118:119] op_sel:[0,0,1] op_sel_hi:[1,0,1]
    v_pk_fma_f32 v[144:145], v[144:145], v[118:119], v[118:119] op_sel:[0,0,1] op_sel_hi:[1,0,1]
    v_pk_fma_f32 v[146:147], v[146:147], v[118:119], v[118:119] op_sel:[0,0,1] op_sel_hi:[1,0,1]
    v_pk_fma_f32 v[148:149], v[148:149], v[118:119], v[118:119] op_sel:[0,0,1] op_sel_hi:[1,0,1]
    v_pk_fma_f32 v[150:151], v[150:151], v[118:119], v[118:119] op_sel:[0,0,1] op_sel_hi:[1,0,1]
    v_pk_fma_f32 v[152:153], v[152:153], v[118:119], v[118:119] op_sel:[0,0,1] op_sel_hi:[1,0,1]
    v_pk_fma_f32 v[154:155], v[154:155], v[118:119], v[118:119] op_sel:[0,0,1] op_sel_hi:[1,0,1]
    v_pk_fma_f32 v[156:157], v[156:157], v[118:119], v[118:119] op_sel:[0,0,1] op_sel_hi:[1,0,1]
    v_pk_fma_f32 v[158:159], v[158:159], v[118:119], v[118:119] op_sel:[0,0,1] op_sel_hi:[1,0,1]
    v_pk_fma_f32 v[160:161], v[160:161], v[118:119], v[118:119] op_sel:[0,0,1] op_sel_hi:[1,0,1]
    v_pk_fma_f32 v[162:163], v[162:163], v[118:119], v[118:119] op_sel:[0,0,1] op_sel_hi:[1,0,1]
    v_pk_fma_f32 v[164:165], v[164:165], v[118:119], v[118:119] op_sel:[0,0,1] op_sel_hi:[1,0,1]
    v_pk_fma_f32 v[166:167], v[166:167], v[118:119], v[118:119] op_sel:[0,0,1] op_sel_hi:[1,0,1]
    v_cvt_pk_bf16_f32 v0, v120, v121
    v_cvt_pk_bf16_f32 v1, v122, v123
    v_cvt_pk_bf16_f32 v2, v124, v125
    v_cvt_pk_bf16_f32 v3, v126, v127
    v_cvt_pk_bf16_f32 v4, v128, v129
    v_cvt_pk_bf16_f32 v5, v130, v131
    v_cvt_pk_bf16_f32 v6, v132, v133
    v_cvt_pk_bf16_f32 v7, v134, v135
    v_cvt_pk_bf16_f32 v8, v136, v137
    v_cvt_pk_bf16_f32 v9, v138, v139
    v_cvt_pk_bf16_f32 v10, v140, v141
    v_cvt_pk_bf16_f32 v11, v142, v143
    v_cvt_pk_bf16_f32 v12, v144, v145
    v_cvt_pk_bf16_f32 v13, v146, v147
    v_cvt_pk_bf16_f32 v14, v148, v149
    v_cvt_pk_bf16_f32 v15, v150, v151
    v_cvt_pk_bf16_f32 v16, v152, v153
    v_cvt_pk_bf16_f32 v17, v154, v155
    v_cvt_pk_bf16_f32 v18, v156, v157
    v_cvt_pk_bf16_f32 v19, v158, v159
    v_cvt_pk_bf16_f32 v20, v160, v161
    v_cvt_pk_bf16_f32 v21, v162, v163
    v_cvt_pk_bf16_f32 v22, v164, v165
    v_cvt_pk_bf16_f32 v23, v166, v167
    s_setprio 0
    s_waitcnt lgkmcnt(0)
    v_mfma_f32_32x32x16_bf16 v[120:135], v[24:27], v[0:3], 0
    ds_read_b64_tr_b16 v[24:25], v228 offset:6144
    ds_read_b64_tr_b16 v[26:27], v228 offset:6656
    v_mfma_f32_32x32x16_bf16 v[120:135], v[28:31], v[4:7], v[120:135]
    ds_read_b64_tr_b16 v[28:29], v228 offset:7168
    ds_read_b64_tr_b16 v[30:31], v228 offset:7680
    v_mfma_f32_32x32x16_bf16 v[120:135], v[32:35], v[8:11], v[120:135]
    ds_read_b64_tr_b16 v[32:33], v228 offset:8192
    ds_read_b64_tr_b16 v[34:35], v228 offset:8704
    v_mfma_f32_32x32x16_bf16 v[120:135], v[36:39], v[12:15], v[120:135]
    ds_read_b64_tr_b16 v[36:37], v228 offset:9216
    ds_read_b64_tr_b16 v[38:39], v228 offset:9728
    v_mfma_f32_32x32x16_bf16 v[120:135], v[40:43], v[16:19], v[120:135]
    ds_read_b64_tr_b16 v[40:41], v228 offset:10240
    ds_read_b64_tr_b16 v[42:43], v228 offset:10752
    v_mfma_f32_32x32x16_bf16 v[120:135], v[44:47], v[20:23], v[120:135]
    ds_read_b64_tr_b16 v[44:45], v228 offset:11264
    ds_read_b64_tr_b16 v[46:47], v228 offset:11776
    s_nop 9
    v_pk_fma_f32 v[168:169], v[120:121], v[120:121], s[92:93] neg_lo:[1,0,0] neg_hi:[1,0,0]
    v_pk_fma_f32 v[170:171], v[122:123], v[122:123], s[92:93] neg_lo:[1,0,0] neg_hi:[1,0,0]
    v_pk_fma_f32 v[172:173], v[124:125], v[124:125], s[92:93] neg_lo:[1,0,0] neg_hi:[1,0,0]
    v_pk_fma_f32 v[174:175], v[126:127], v[126:127], s[92:93] neg_lo:[1,0,0] neg_hi:[1,0,0]
    v_pk_fma_f32 v[176:177], v[128:129], v[128:129], s[92:93] neg_lo:[1,0,0] neg_hi:[1,0,0]
    v_pk_fma_f32 v[178:179], v[130:131], v[130:131], s[92:93] neg_lo:[1,0,0] neg_hi:[1,0,0]
    v_pk_fma_f32 v[180:181], v[132:133], v[132:133], s[92:93] neg_lo:[1,0,0] neg_hi:[1,0,0]
    v_pk_fma_f32 v[182:183], v[134:135], v[134:135], s[92:93] neg_lo:[1,0,0] neg_hi:[1,0,0]
    v_pk_mul_f32 v[168:169], v[120:121], v[168:169]
    v_pk_mul_f32 v[170:171], v[122:123], v[170:171]
    v_pk_mul_f32 v[172:173], v[124:125], v[172:173]
    v_pk_mul_f32 v[174:175], v[126:127], v[174:175]
    v_pk_mul_f32 v[176:177], v[128:129], v[176:177]
    v_pk_mul_f32 v[178:179], v[130:131], v[178:179]
    v_pk_mul_f32 v[180:181], v[132:133], v[180:181]
    v_pk_mul_f32 v[182:183], v[134:135], v[182:183]
    s_barrier
    s_waitcnt lgkmcnt(0)
    v_mfma_f32_32x32x16_bf16 v[136:151], v[24:27], v[0:3], 0
    ds_read_b64_tr_b16 v[24:25], v228 offset:12288
    ds_read_b64_tr_b16 v[26:27], v228 offset:12800
    v_exp_f32 v168, v168
    v_exp_f32 v169, v169
    v_exp_f32 v170, v170
    v_mfma_f32_32x32x16_bf16 v[136:151], v[28:31], v[4:7], v[136:151]
    ds_read_b64_tr_b16 v[28:29], v228 offset:13312
    ds_read_b64_tr_b16 v[30:31], v228 offset:13824
    v_exp_f32 v171, v171
    v_exp_f32 v172, v172
    v_exp_f32 v173, v173
    v_mfma_f32_32x32x16_bf16 v[136:151], v[32:35], v[8:11], v[136:151]
    ds_read_b64_tr_b16 v[32:33], v228 offset:14336
    ds_read_b64_tr_b16 v[34:35], v228 offset:14848
    v_exp_f32 v174, v174
    v_exp_f32 v175, v175
    v_exp_f32 v176, v176
    v_mfma_f32_32x32x16_bf16 v[136:151], v[36:39], v[12:15], v[136:151]
    ds_read_b64_tr_b16 v[36:37], v228 offset:15360
    ds_read_b64_tr_b16 v[38:39], v228 offset:15872
    v_exp_f32 v177, v177
    v_exp_f32 v178, v178
    v_exp_f32 v179, v179
    v_mfma_f32_32x32x16_bf16 v[136:151], v[40:43], v[16:19], v[136:151]
    ds_read_b64_tr_b16 v[40:41], v228 offset:16384
    ds_read_b64_tr_b16 v[42:43], v228 offset:16896
    v_exp_f32 v180, v180
    v_exp_f32 v181, v181
    v_exp_f32 v182, v182
    v_mfma_f32_32x32x16_bf16 v[136:151], v[44:47], v[20:23], v[136:151]
    ds_read_b64_tr_b16 v[44:45], v228 offset:17408
    ds_read_b64_tr_b16 v[46:47], v228 offset:17920
    v_exp_f32 v183, v183
    v_pk_fma_f32 v[168:169], v[168:169], s[94:95], s[94:95]
    v_pk_fma_f32 v[170:171], v[170:171], s[94:95], s[94:95]
    v_pk_fma_f32 v[172:173], v[172:173], s[94:95], s[94:95]
    v_pk_fma_f32 v[174:175], v[174:175], s[94:95], s[94:95]
    v_pk_fma_f32 v[176:177], v[176:177], s[94:95], s[94:95]
    v_pk_fma_f32 v[178:179], v[178:179], s[94:95], s[94:95]
    v_pk_fma_f32 v[180:181], v[180:181], s[94:95], s[94:95]
    v_pk_fma_f32 v[182:183], v[182:183], s[94:95], s[94:95]
    s_nop 0
    v_pk_fma_f32 v[184:185], v[136:137], v[136:137], s[92:93] neg_lo:[1,0,0] neg_hi:[1,0,0]
    v_pk_fma_f32 v[186:187], v[138:139], v[138:139], s[92:93] neg_lo:[1,0,0] neg_hi:[1,0,0]
    v_pk_fma_f32 v[188:189], v[140:141], v[140:141], s[92:93] neg_lo:[1,0,0] neg_hi:[1,0,0]
    v_pk_fma_f32 v[190:191], v[142:143], v[142:143], s[92:93] neg_lo:[1,0,0] neg_hi:[1,0,0]
    v_pk_fma_f32 v[192:193], v[144:145], v[144:145], s[92:93] neg_lo:[1,0,0] neg_hi:[1,0,0]
    v_pk_fma_f32 v[194:195], v[146:147], v[146:147], s[92:93] neg_lo:[1,0,0] neg_hi:[1,0,0]
    v_pk_fma_f32 v[196:197], v[148:149], v[148:149], s[92:93] neg_lo:[1,0,0] neg_hi:[1,0,0]
    v_pk_fma_f32 v[198:199], v[150:151], v[150:151], s[92:93] neg_lo:[1,0,0] neg_hi:[1,0,0]
    v_pk_mul_f32 v[184:185], v[136:137], v[184:185]
    v_pk_mul_f32 v[186:187], v[138:139], v[186:187]
    v_pk_mul_f32 v[188:189], v[140:141], v[188:189]
    v_pk_mul_f32 v[190:191], v[142:143], v[190:191]
    v_pk_mul_f32 v[192:193], v[144:145], v[192:193]
    v_pk_mul_f32 v[194:195], v[146:147], v[194:195]
    v_pk_mul_f32 v[196:197], v[148:149], v[196:197]
    v_pk_mul_f32 v[198:199], v[150:151], v[198:199]
    s_barrier
    s_waitcnt lgkmcnt(0)
    v_mfma_f32_32x32x16_bf16 v[152:167], v[24:27], v[0:3], 0
    ds_read_b64_tr_b16 v[24:25], v228 offset:18432
    ds_read_b64_tr_b16 v[26:27], v228 offset:18944
    ds_read_b64_tr_b16 v[48:49], v229 offset:0
    ds_read_b64_tr_b16 v[50:51], v229 offset:512
    v_exp_f32 v184, v184
    v_rcp_f32 v168, v168
    v_exp_f32 v185, v185
    v_mfma_f32_32x32x16_bf16 v[152:167], v[28:31], v[4:7], v[152:167]
    ds_read_b64_tr_b16 v[28:29], v228 offset:19456
    ds_read_b64_tr_b16 v[30:31], v228 offset:19968
    ds_read_b64_tr_b16 v[52:53], v229 offset:1024
    ds_read_b64_tr_b16 v[54:55], v229 offset:1536
    v_rcp_f32 v169, v169
    v_exp_f32 v186, v186
    v_rcp_f32 v170, v170
    v_mfma_f32_32x32x16_bf16 v[152:167], v[32:35], v[8:11], v[152:167]
    ds_read_b64_tr_b16 v[32:33], v228 offset:20480
    ds_read_b64_tr_b16 v[34:35], v228 offset:20992
    ds_read_b64_tr_b16 v[56:57], v229 offset:2048
    ds_read_b64_tr_b16 v[58:59], v229 offset:2560
    v_exp_f32 v187, v187
    v_rcp_f32 v171, v171
    v_exp_f32 v188, v188
    v_mfma_f32_32x32x16_bf16 v[152:167], v[36:39], v[12:15], v[152:167]
    ds_read_b64_tr_b16 v[36:37], v228 offset:21504
    ds_read_b64_tr_b16 v[38:39], v228 offset:22016
    ds_read_b64_tr_b16 v[60:61], v229 offset:3072
    ds_read_b64_tr_b16 v[62:63], v229 offset:3584
    v_rcp_f32 v172, v172
    v_exp_f32 v189, v189
    v_rcp_f32 v173, v173
    v_mfma_f32_32x32x16_bf16 v[152:167], v[40:43], v[16:19], v[152:167]
    ds_read_b64_tr_b16 v[40:41], v228 offset:22528
    ds_read_b64_tr_b16 v[42:43], v228 offset:23040
    ds_read_b64_tr_b16 v[64:65], v229 offset:4096
    ds_read_b64_tr_b16 v[66:67], v229 offset:4608
    v_exp_f32 v190, v190
    v_rcp_f32 v174, v174
    v_exp_f32 v191, v191
    v_mfma_f32_32x32x16_bf16 v[152:167], v[44:47], v[20:23], v[152:167]
    ds_read_b64_tr_b16 v[44:45], v228 offset:23552
    ds_read_b64_tr_b16 v[46:47], v228 offset:24064
    ds_read_b64_tr_b16 v[68:69], v229 offset:5120
    ds_read_b64_tr_b16 v[70:71], v229 offset:5632
    v_rcp_f32 v175, v175
    v_exp_f32 v192, v192
    v_rcp_f32 v176, v176
    v_exp_f32 v193, v193
    v_rcp_f32 v177, v177
    v_exp_f32 v194, v194
    v_rcp_f32 v178, v178
    v_exp_f32 v195, v195
    v_rcp_f32 v179, v179
    v_exp_f32 v196, v196
    v_rcp_f32 v180, v180
    v_exp_f32 v197, v197
    v_rcp_f32 v181, v181
    v_exp_f32 v198, v198
    v_rcp_f32 v182, v182
    v_exp_f32 v199, v199
    v_rcp_f32 v183, v183
    v_pk_mul_f32 v[168:169], v[120:121], v[168:169]
    v_pk_mul_f32 v[170:171], v[122:123], v[170:171]
    v_pk_mul_f32 v[172:173], v[124:125], v[172:173]
    v_pk_mul_f32 v[174:175], v[126:127], v[174:175]
    v_pk_mul_f32 v[176:177], v[128:129], v[176:177]
    v_pk_mul_f32 v[178:179], v[130:131], v[178:179]
    v_pk_mul_f32 v[180:181], v[132:133], v[180:181]
    v_pk_mul_f32 v[182:183], v[134:135], v[182:183]
    v_pk_fma_f32 v[184:185], v[184:185], s[94:95], s[94:95]
    v_pk_fma_f32 v[186:187], v[186:187], s[94:95], s[94:95]
    v_pk_fma_f32 v[188:189], v[188:189], s[94:95], s[94:95]
    v_pk_fma_f32 v[190:191], v[190:191], s[94:95], s[94:95]
    v_pk_fma_f32 v[192:193], v[192:193], s[94:95], s[94:95]
    v_pk_fma_f32 v[194:195], v[194:195], s[94:95], s[94:95]
    v_pk_fma_f32 v[196:197], v[196:197], s[94:95], s[94:95]
    v_pk_fma_f32 v[198:199], v[198:199], s[94:95], s[94:95]
    v_pk_fma_f32 v[200:201], v[152:153], v[152:153], s[92:93] neg_lo:[1,0,0] neg_hi:[1,0,0]
    v_pk_fma_f32 v[202:203], v[154:155], v[154:155], s[92:93] neg_lo:[1,0,0] neg_hi:[1,0,0]
    v_pk_fma_f32 v[204:205], v[156:157], v[156:157], s[92:93] neg_lo:[1,0,0] neg_hi:[1,0,0]
    v_pk_fma_f32 v[206:207], v[158:159], v[158:159], s[92:93] neg_lo:[1,0,0] neg_hi:[1,0,0]
    v_pk_fma_f32 v[208:209], v[160:161], v[160:161], s[92:93] neg_lo:[1,0,0] neg_hi:[1,0,0]
    v_pk_fma_f32 v[210:211], v[162:163], v[162:163], s[92:93] neg_lo:[1,0,0] neg_hi:[1,0,0]
    v_pk_fma_f32 v[212:213], v[164:165], v[164:165], s[92:93] neg_lo:[1,0,0] neg_hi:[1,0,0]
    v_pk_fma_f32 v[214:215], v[166:167], v[166:167], s[92:93] neg_lo:[1,0,0] neg_hi:[1,0,0]
    v_pk_mul_f32 v[200:201], v[152:153], v[200:201]
    v_pk_mul_f32 v[202:203], v[154:155], v[202:203]
    v_pk_mul_f32 v[204:205], v[156:157], v[204:205]
    v_pk_mul_f32 v[206:207], v[158:159], v[206:207]
    v_pk_mul_f32 v[208:209], v[160:161], v[208:209]
    v_pk_mul_f32 v[210:211], v[162:163], v[210:211]
    v_pk_mul_f32 v[212:213], v[164:165], v[212:213]
    v_pk_mul_f32 v[214:215], v[166:167], v[214:215]
    s_barrier
    s_waitcnt lgkmcnt(2)
    v_mfma_f32_32x32x16_bf16 v[120:135], v[24:27], v[0:3], 0
    ds_read_b64_tr_b16 v[24:25], v228 offset:24576
    ds_read_b64_tr_b16 v[26:27], v228 offset:25088
    v_cvt_pk_bf16_f32 v216, v168, v169
    v_cvt_pk_bf16_f32 v217, v170, v171
    v_cvt_pk_bf16_f32 v218, v172, v173
    v_cvt_pk_bf16_f32 v219, v174, v175
    v_cvt_pk_bf16_f32 v220, v176, v177
    v_cvt_pk_bf16_f32 v221, v178, v179
    v_mfma_f32_32x32x16_bf16 v[120:135], v[28:31], v[4:7], v[120:135]
    ds_read_b64_tr_b16 v[28:29], v228 offset:25600
    ds_read_b64_tr_b16 v[30:31], v228 offset:26112
    v_cvt_pk_bf16_f32 v222, v180, v181
    v_cvt_pk_bf16_f32 v223, v182, v183
    v_exp_f32 v200, v200
    v_rcp_f32 v184, v184
    v_mfma_f32_32x32x16_bf16 v[120:135], v[32:35], v[8:11], v[120:135]
    ds_read_b64_tr_b16 v[32:33], v228 offset:26624
    ds_read_b64_tr_b16 v[34:35], v228 offset:27136
    v_exp_f32 v201, v201
    v_rcp_f32 v185, v185
    v_exp_f32 v202, v202
    v_mfma_f32_32x32x16_bf16 v[120:135], v[36:39], v[12:15], v[120:135]
    ds_read_b64_tr_b16 v[36:37], v228 offset:27648
    ds_read_b64_tr_b16 v[38:39], v228 offset:28160
    v_rcp_f32 v186, v186
    v_exp_f32 v203, v203
    v_rcp_f32 v187, v187
    v_mfma_f32_32x32x16_bf16 v[120:135], v[40:43], v[16:19], v[120:135]
    ds_read_b64_tr_b16 v[40:41], v228 offset:28672
    ds_read_b64_tr_b16 v[42:43], v228 offset:29184
    v_exp_f32 v204, v204
    v_rcp_f32 v188, v188
    v_exp_f32 v205, v205
    v_mfma_f32_32x32x16_bf16 v[120:135], v[44:47], v[20:23], v[120:135]
    ds_read_b64_tr_b16 v[44:45], v228 offset:29696
    ds_read_b64_tr_b16 v[46:47], v228 offset:30208
    v_rcp_f32 v189, v189
    v_exp_f32 v206, v206
    v_rcp_f32 v190, v190
    s_waitcnt lgkmcnt(12)
    v_mfma_f32_32x32x16_bf16 v[72:87], v[48:51], v[216:219], 0
    ds_read_b64_tr_b16 v[48:49], v229 offset:6144
    ds_read_b64_tr_b16 v[50:51], v229 offset:6656
    v_exp_f32 v207, v207
    v_rcp_f32 v191, v191
    v_exp_f32 v208, v208
    v_mfma_f32_32x32x16_bf16 v[88:103], v[52:55], v[216:219], 0
    ds_read_b64_tr_b16 v[52:53], v229 offset:7168
    ds_read_b64_tr_b16 v[54:55], v229 offset:7680
    v_rcp_f32 v192, v192
    v_exp_f32 v209, v209
    v_rcp_f32 v193, v193
    v_mfma_f32_32x32x16_bf16 v[104:119], v[56:59], v[216:219], 0
    ds_read_b64_tr_b16 v[56:57], v229 offset:8192
    ds_read_b64_tr_b16 v[58:59], v229 offset:8704
    v_exp_f32 v210, v210
    v_rcp_f32 v194, v194
    v_exp_f32 v211, v211
    v_mfma_f32_32x32x16_bf16 v[72:87], v[60:63], v[220:223], v[72:87]
    ds_read_b64_tr_b16 v[60:61], v229 offset:9216
    ds_read_b64_tr_b16 v[62:63], v229 offset:9728
    v_rcp_f32 v195, v195
    v_exp_f32 v212, v212
    v_rcp_f32 v196, v196
    v_mfma_f32_32x32x16_bf16 v[88:103], v[64:67], v[220:223], v[88:103]
    ds_read_b64_tr_b16 v[64:65], v229 offset:10240
    ds_read_b64_tr_b16 v[66:67], v229 offset:10752
    v_exp_f32 v213, v213
    v_rcp_f32 v197, v197
    v_exp_f32 v214, v214
    v_mfma_f32_32x32x16_bf16 v[104:119], v[68:71], v[220:223], v[104:119]
    ds_read_b64_tr_b16 v[68:69], v229 offset:11264
    ds_read_b64_tr_b16 v[70:71], v229 offset:11776
    v_rcp_f32 v198, v198
    v_exp_f32 v215, v215
    v_rcp_f32 v199, v199
    v_pk_mul_f32 v[184:185], v[136:137], v[184:185]
    v_pk_mul_f32 v[186:187], v[138:139], v[186:187]
    v_pk_mul_f32 v[188:189], v[140:141], v[188:189]
    v_pk_mul_f32 v[190:191], v[142:143], v[190:191]
    v_pk_mul_f32 v[192:193], v[144:145], v[192:193]
    v_pk_mul_f32 v[194:195], v[146:147], v[194:195]
    v_pk_mul_f32 v[196:197], v[148:149], v[196:197]
    v_pk_mul_f32 v[198:199], v[150:151], v[198:199]
    v_pk_fma_f32 v[200:201], v[200:201], s[94:95], s[94:95]
    v_pk_fma_f32 v[202:203], v[202:203], s[94:95], s[94:95]
    v_pk_fma_f32 v[204:205], v[204:205], s[94:95], s[94:95]
    v_pk_fma_f32 v[206:207], v[206:207], s[94:95], s[94:95]
    v_pk_fma_f32 v[208:209], v[208:209], s[94:95], s[94:95]
    v_pk_fma_f32 v[210:211], v[210:211], s[94:95], s[94:95]
    v_pk_fma_f32 v[212:213], v[212:213], s[94:95], s[94:95]
    v_pk_fma_f32 v[214:215], v[214:215], s[94:95], s[94:95]
    v_pk_fma_f32 v[168:169], v[120:121], v[120:121], s[92:93] neg_lo:[1,0,0] neg_hi:[1,0,0]
    v_pk_fma_f32 v[170:171], v[122:123], v[122:123], s[92:93] neg_lo:[1,0,0] neg_hi:[1,0,0]
    v_pk_fma_f32 v[172:173], v[124:125], v[124:125], s[92:93] neg_lo:[1,0,0] neg_hi:[1,0,0]
    v_pk_fma_f32 v[174:175], v[126:127], v[126:127], s[92:93] neg_lo:[1,0,0] neg_hi:[1,0,0]
    v_pk_fma_f32 v[176:177], v[128:129], v[128:129], s[92:93] neg_lo:[1,0,0] neg_hi:[1,0,0]
    v_pk_fma_f32 v[178:179], v[130:131], v[130:131], s[92:93] neg_lo:[1,0,0] neg_hi:[1,0,0]
    v_pk_fma_f32 v[180:181], v[132:133], v[132:133], s[92:93] neg_lo:[1,0,0] neg_hi:[1,0,0]
    v_pk_fma_f32 v[182:183], v[134:135], v[134:135], s[92:93] neg_lo:[1,0,0] neg_hi:[1,0,0]
    v_pk_mul_f32 v[168:169], v[120:121], v[168:169]
    v_pk_mul_f32 v[170:171], v[122:123], v[170:171]
    v_pk_mul_f32 v[172:173], v[124:125], v[172:173]
    v_pk_mul_f32 v[174:175], v[126:127], v[174:175]
    v_pk_mul_f32 v[176:177], v[128:129], v[176:177]
    v_pk_mul_f32 v[178:179], v[130:131], v[178:179]
    v_pk_mul_f32 v[180:181], v[132:133], v[180:181]
    v_pk_mul_f32 v[182:183], v[134:135], v[182:183]
    s_mov_b32 s58, 0
L_loop:
    s_barrier
    s_cmp_eq_u32 s58, 0
    s_cbranch_scc1 L_nx
    buffer_load_dwordx4 v[232:235], v230, s[16:19], 0 offen offset:0
    buffer_load_dwordx4 v[236:239], v230, s[16:19], 0 offen offset:16
    buffer_load_dwordx4 v[240:243], v230, s[16:19], 0 offen offset:32
    buffer_load_dwordx4 v[244:247], v230, s[16:19], 0 offen offset:48
    buffer_load_dwordx4 v[248:251], v230, s[16:19], 0 offen offset:64
    buffer_load_dwordx4 v[252:255], v230, s[16:19], 0 offen offset:80
L_nx:
    s_waitcnt lgkmcnt(12)
    v_mfma_f32_32x32x16_bf16 v[136:151], v[24:27], v[0:3], 0
    ds_read_b64_tr_b16 v[24:25], v228 offset:30720
    ds_read_b64_tr_b16 v[26:27], v228 offset:31232
    v_cvt_pk_bf16_f32 v216, v184, v185
    v_cvt_pk_bf16_f32 v217, v186, v187
    v_cvt_pk_bf16_f32 v218, v188, v189
    v_cvt_pk_bf16_f32 v219, v190, v191
    v_cvt_pk_bf16_f32 v220, v192, v193
    v_cvt_pk_bf16_f32 v221, v194, v195
    v_mfma_f32_32x32x16_bf16 v[136:151], v[28:31], v[4:7], v[136:151]
    ds_read_b64_tr_b16 v[28:29], v228 offset:31744
    ds_read_b64_tr_b16 v[30:31], v228 offset:32256
    v_cvt_pk_bf16_f32 v222, v196, v197
    v_cvt_pk_bf16_f32 v223, v198, v199
    v_exp_f32 v168, v168
    v_rcp_f32 v200, v200
    v_mfma_f32_32x32x16_bf16 v[136:151], v[32:35], v[8:11], v[136:151]
    ds_read_b64_tr_b16 v[32:33], v228 offset:32768
    ds_read_b64_tr_b16 v[34:35], v228 offset:33280
    v_exp_f32 v169, v169
    v_rcp_f32 v201, v201
    v_exp_f32 v170, v170
    v_mfma_f32_32x32x16_bf16 v[136:151], v[36:39], v[12:15], v[136:151]
    ds_read_b64_tr_b16 v[36:37], v228 offset:33792
    ds_read_b64_tr_b16 v[38:39], v228 offset:34304
    v_rcp_f32 v202, v202
    v_exp_f32 v171, v171
    v_rcp_f32 v203, v203
    v_mfma_f32_32x32x16_bf16 v[136:151], v[40:43], v[16:19], v[136:151]
    ds_read_b64_tr_b16 v[40:41], v228 offset:34816
    ds_read_b64_tr_b16 v[42:43], v228 offset:35328
    v_exp_f32 v172, v172
    v_rcp_f32 v204, v204
    v_exp_f32 v173, v173
    v_mfma_f32_32x32x16_bf16 v[136:151], v[44:47], v[20:23], v[136:151]
    ds_read_b64_tr_b16 v[44:45], v228 offset:35840
    ds_read_b64_tr_b16 v[46:47], v228 offset:36352
    v_rcp_f32 v205, v205
    v_exp_f32 v174, v174
    v_rcp_f32 v206, v206
    s_waitcnt lgkmcnt(12)
    v_mfma_f32_32x32x16_bf16 v[72:87], v[48:51], v[216:219], v[72:87]
    ds_read_b64_tr_b16 v[48:49], v229 offset:12288
    ds_read_b64_tr_b16 v[50:51], v229 offset:12800
    v_exp_f32 v175, v175
    v_rcp_f32 v207, v207
    v_exp_f32 v176, v176
    v_mfma_f32_32x32x16_bf16 v[88:103], v[52:55], v[216:219], v[88:103]
    ds_read_b64_tr_b16 v[52:53], v229 offset:13312
    ds_read_b64_tr_b16 v[54:55], v229 offset:13824
    v_rcp_f32 v208, v208
    v_exp_f32 v177, v177
    v_rcp_f32 v209, v209
    v_mfma_f32_32x32x16_bf16 v[104:119], v[56:59], v[216:219], v[104:119]
    ds_read_b64_tr_b16 v[56:57], v229 offset:14336
    ds_read_b64_tr_b16 v[58:59], v229 offset:14848
    v_exp_f32 v178, v178
    v_rcp_f32 v210, v210
    v_exp_f32 v179, v179
    v_mfma_f32_32x32x16_bf16 v[72:87], v[60:63], v[220:223], v[72:87]
    ds_read_b64_tr_b16 v[60:61], v229 offset:15360
    ds_read_b64_tr_b16 v[62:63], v229 offset:15872
    v_rcp_f32 v211, v211
    v_exp_f32 v180, v180
    v_rcp_f32 v212, v212
    v_mfma_f32_32x32x16_bf16 v[88:103], v[64:67], v[220:223], v[88:103]
    ds_read_b64_tr_b16 v[64:65], v229 offset:16384
    ds_read_b64_tr_b16 v[66:67], v229 offset:16896
    v_exp_f32 v181, v181
    v_rcp_f32 v213, v213
    v_exp_f32 v182, v182
    v_mfma_f32_32x32x16_bf16 v[104:119], v[68:71], v[220:223], v[104:119]
    ds_read_b64_tr_b16 v[68:69], v229 offset:17408
    ds_read_b64_tr_b16 v[70:71], v229 offset:17920
    v_rcp_f32 v214, v214
    v_exp_f32 v183, v183
    v_rcp_f32 v215, v215
    v_pk_mul_f32 v[200:201], v[152:153], v[200:201]
    v_pk_mul_f32 v[202:203], v[154:155], v[202:203]
    v_pk_mul_f32 v[204:205], v[156:157], v[204:205]
    v_pk_mul_f32 v[206:207], v[158:159], v[206:207]
    v_pk_mul_f32 v[208:209], v[160:161], v[208:209]
    v_pk_mul_f32 v[210:211], v[162:163], v[210:211]
    v_pk_mul_f32 v[212:213], v[164:165], v[212:213]
    v_pk_mul_f32 v[214:215], v[166:167], v[214:215]
    v_pk_fma_f32 v[168:169], v[168:169], s[94:95], s[94:95]
    v_pk_fma_f32 v[170:171], v[170:171], s[94:95], s[94:95]
    v_pk_fma_f32 v[172:173], v[172:173], s[94:95], s[94:95]
    v_pk_fma_f32 v[174:175], v[174:175], s[94:95], s[94:95]
    v_pk_fma_f32 v[176:177], v[176:177], s[94:95], s[94:95]
    v_pk_fma_f32 v[178:179], v[178:179], s[94:95], s[94:95]
    v_pk_fma_f32 v[180:181], v[180:181], s[94:95], s[94:95]
    v_pk_fma_f32 v[182:183], v[182:183], s[94:95], s[94:95]
    v_pk_fma_f32 v[184:185], v[136:137], v[136:137], s[92:93] neg_lo:[1,0,0] neg_hi:[1,0,0]
    v_pk_fma_f32 v[186:187], v[138:139], v[138:139], s[92:93] neg_lo:[1,0,0] neg_hi:[1,0,0]
    v_pk_fma_f32 v[188:189], v[140:141], v[140:141], s[92:93] neg_lo:[1,0,0] neg_hi:[1,0,0]
    v_pk_fma_f32 v[190:191], v[142:143], v[142:143], s[92:93] neg_lo:[1,0,0] neg_hi:[1,0,0]
    v_pk_fma_f32 v[192:193], v[144:145], v[144:145], s[92:93] neg_lo:[1,0,0] neg_hi:[1,0,0]
    v_pk_fma_f32 v[194:195], v[146:147], v[146:147], s[92:93] neg_lo:[1,0,0] neg_hi:[1,0,0]
    v_pk_fma_f32 v[196:197], v[148:149], v[148:149], s[92:93] neg_lo:[1,0,0] neg_hi:[1,0,0]
    v_pk_fma_f32 v[198:199], v[150:151], v[150:151], s[92:93] neg_lo:[1,0,0] neg_hi:[1,0,0]
    v_pk_mul_f32 v[184:185], v[136:137], v[184:185]
    v_pk_mul_f32 v[186:187], v[138:139], v[186:187]
    v_pk_mul_f32 v[188:189], v[140:141], v[188:189]
    v_pk_mul_f32 v[190:191], v[142:143], v[190:191]
    v_pk_mul_f32 v[192:193], v[144:145], v[192:193]
    v_pk_mul_f32 v[194:195], v[146:147], v[194:195]
    v_pk_mul_f32 v[196:197], v[148:149], v[196:197]
    v_pk_mul_f32 v[198:199], v[150:151], v[198:199]
    s_barrier
    s_waitcnt lgkmcnt(12)
    v_mfma_f32_32x32x16_bf16 v[152:167], v[24:27], v[0:3], 0
    ds_read_b64_tr_b16 v[24:25], v228 offset:36864
    ds_read_b64_tr_b16 v[26:27], v228 offset:37376
    v_cvt_pk_bf16_f32 v216, v200, v201
    v_cvt_pk_bf16_f32 v217, v202, v203
    v_cvt_pk_bf16_f32 v218, v204, v205
    v_cvt_pk_bf16_f32 v219, v206, v207
    v_cvt_pk_bf16_f32 v220, v208, v209
    v_cvt_pk_bf16_f32 v221, v210, v211
    v_mfma_f32_32x32x16_bf16 v[152:167], v[28:31], v[4:7], v[152:167]
    ds_read_b64_tr_b16 v[28:29], v228 offset:37888
    ds_read_b64_tr_b16 v[30:31], v228 offset:38400
    v_cvt_pk_bf16_f32 v222, v212, v213
    v_cvt_pk_bf16_f32 v223, v214, v215
    v_exp_f32 v184, v184
    v_rcp_f32 v168, v168
    v_mfma_f32_32x32x16_bf16 v[152:167], v[32:35], v[8:11], v[152:167]
    ds_read_b64_tr_b16 v[32:33], v228 offset:38912
    ds_read_b64_tr_b16 v[34:35], v228 offset:39424
    v_exp_f32 v185, v185
    v_rcp_f32 v169, v169
    v_exp_f32 v186, v186
    v_mfma_f32_32x32x16_bf16 v[152:167], v[36:39], v[12:15], v[152:167]
    ds_read_b64_tr_b16 v[36:37], v228 offset:39936
    ds_read_b64_tr_b16 v[38:39], v228 offset:40448
    v_rcp_f32 v170, v170
    v_exp_f32 v187, v187
    v_rcp_f32 v171, v171
    v_mfma_f32_32x32x16_bf16 v[152:167], v[40:43], v[16:19], v[152:167]
    ds_read_b64_tr_b16 v[40:41], v228 offset:40960
    ds_read_b64_tr_b16 v[42:43], v228 offset:41472
    v_exp_f32 v188, v188
    v_rcp_f32 v172, v172
    v_exp_f32 v189, v189
    v_mfma_f32_32x32x16_bf16 v[152:167], v[44:47], v[20:23], v[152:167]
    ds_read_b64_tr_b16 v[44:45], v228 offset:41984
    ds_read_b64_tr_b16 v[46:47], v228 offset:42496
    v_rcp_f32 v173, v173
    v_exp_f32 v190, v190
    v_rcp_f32 v174, v174
    s_waitcnt lgkmcnt(12)
    v_mfma_f32_32x32x16_bf16 v[72:87], v[48:51], v[216:219], v[72:87]
    ds_read_b64_tr_b16 v[48:49], v229 offset:18432
    ds_read_b64_tr_b16 v[50:51], v229 offset:18944
    v_exp_f32 v191, v191
    v_rcp_f32 v175, v175
    v_exp_f32 v192, v192
    v_mfma_f32_32x32x16_bf16 v[88:103], v[52:55], v[216:219], v[88:103]
    ds_read_b64_tr_b16 v[52:53], v229 offset:19456
    ds_read_b64_tr_b16 v[54:55], v229 offset:19968
    v_rcp_f32 v176, v176
    v_exp_f32 v193, v193
    v_rcp_f32 v177, v177
    v_mfma_f32_32x32x16_bf16 v[104:119], v[56:59], v[216:219], v[104:119]
    ds_read_b64_tr_b16 v[56:57], v229 offset:20480
    ds_read_b64_tr_b16 v[58:59], v229 offset:20992
    v_exp_f32 v194, v194
    v_rcp_f32 v178, v178
    v_exp_f32 v195, v195
    v_mfma_f32_32x32x16_bf16 v[72:87], v[60:63], v[220:223], v[72:87]
    ds_read_b64_tr_b16 v[60:61], v229 offset:21504
    ds_read_b64_tr_b16 v[62:63], v229 offset:22016
    v_rcp_f32 v179, v179
    v_exp_f32 v196, v196
    v_rcp_f32 v180, v180
    v_mfma_f32_32x32x16_bf16 v[88:103], v[64:67], v[220:223], v[88:103]
    ds_read_b64_tr_b16 v[64:65], v229 offset:22528
    ds_read_b64_tr_b16 v[66:67], v229 offset:23040
    v_exp_f32 v197, v197
    v_rcp_f32 v181, v181
    v_exp_f32 v198, v198
    v_mfma_f32_32x32x16_bf16 v[104:119], v[68:71], v[220:223], v[104:119]
    ds_read_b64_tr_b16 v[68:69], v229 offset:23552
    ds_read_b64_tr_b16 v[70:71], v229 offset:24064
    v_rcp_f32 v182, v182
    v_exp_f32 v199, v199
    v_rcp_f32 v183, v183
    v_pk_mul_f32 v[168:169], v[120:121], v[168:169]
    v_pk_mul_f32 v[170:171], v[122:123], v[170:171]
    v_pk_mul_f32 v[172:173], v[124:125], v[172:173]
    v_pk_mul_f32 v[174:175], v[126:127], v[174:175]
    v_pk_mul_f32 v[176:177], v[128:129], v[176:177]
    v_pk_mul_f32 v[178:179], v[130:131], v[178:179]
    v_pk_mul_f32 v[180:181], v[132:133], v[180:181]
    v_pk_mul_f32 v[182:183], v[134:135], v[182:183]
    v_pk_fma_f32 v[184:185], v[184:185], s[94:95], s[94:95]
    v_pk_fma_f32 v[186:187], v[186:187], s[94:95], s[94:95]
    v_pk_fma_f32 v[188:189], v[188:189], s[94:95], s[94:95]
    v_pk_fma_f32 v[190:191], v[190:191], s[94:95], s[94:95]
    v_pk_fma_f32 v[192:193], v[192:193], s[94:95], s[94:95]
    v_pk_fma_f32 v[194:195], v[194:195], s[94:95], s[94:95]
    v_pk_fma_f32 v[196:197], v[196:197], s[94:95], s[94:95]
    v_pk_fma_f32 v[198:199], v[198:199], s[94:95], s[94:95]
    v_pk_fma_f32 v[200:201], v[152:153], v[152:153], s[92:93] neg_lo:[1,0,0] neg_hi:[1,0,0]
    v_pk_fma_f32 v[202:203], v[154:155], v[154:155], s[92:93] neg_lo:[1,0,0] neg_hi:[1,0,0]
    v_pk_fma_f32 v[204:205], v[156:157], v[156:157], s[92:93] neg_lo:[1,0,0] neg_hi:[1,0,0]
    v_pk_fma_f32 v[206:207], v[158:159], v[158:159], s[92:93] neg_lo:[1,0,0] neg_hi:[1,0,0]
    v_pk_fma_f32 v[208:209], v[160:161], v[160:161], s[92:93] neg_lo:[1,0,0] neg_hi:[1,0,0]
    v_pk_fma_f32 v[210:211], v[162:163], v[162:163], s[92:93] neg_lo:[1,0,0] neg_hi:[1,0,0]
    v_pk_fma_f32 v[212:213], v[164:165], v[164:165], s[92:93] neg_lo:[1,0,0] neg_hi:[1,0,0]
    v_pk_fma_f32 v[214:215], v[166:167], v[166:167], s[92:93] neg_lo:[1,0,0] neg_hi:[1,0,0]
    v_pk_mul_f32 v[200:201], v[152:153], v[200:201]
    v_pk_mul_f32 v[202:203], v[154:155], v[202:203]
    v_pk_mul_f32 v[204:205], v[156:157], v[204:205]
    v_pk_mul_f32 v[206:207], v[158:159], v[206:207]
    v_pk_mul_f32 v[208:209], v[160:161], v[208:209]
    v_pk_mul_f32 v[210:211], v[162:163], v[210:211]
    v_pk_mul_f32 v[212:213], v[164:165], v[212:213]
    v_pk_mul_f32 v[214:215], v[166:167], v[214:215]
    s_barrier
    s_waitcnt lgkmcnt(12)
    v_mfma_f32_32x32x16_bf16 v[120:135], v[24:27], v[0:3], 0
    ds_read_b64_tr_b16 v[24:25], v228 offset:43008
    ds_read_b64_tr_b16 v[26:27], v228 offset:43520
    v_cvt_pk_bf16_f32 v216, v168, v169
    v_cvt_pk_bf16_f32 v217, v170, v171
    v_cvt_pk_bf16_f32 v218, v172, v173
    v_cvt_pk_bf16_f32 v219, v174, v175
    v_cvt_pk_bf16_f32 v220, v176, v177
    v_cvt_pk_bf16_f32 v221, v178, v179
    v_mfma_f32_32x32x16_bf16 v[120:135], v[28:31], v[4:7], v[120:135]
    ds_read_b64_tr_b16 v[28:29], v228 offset:44032
    ds_read_b64_tr_b16 v[30:31], v228 offset:44544
    v_cvt_pk_bf16_f32 v222, v180, v181
    v_cvt_pk_bf16_f32 v223, v182, v183
    v_exp_f32 v200, v200
    v_rcp_f32 v184, v184
    v_mfma_f32_32x32x16_bf16 v[120:135], v[32:35], v[8:11], v[120:135]
    ds_read_b64_tr_b16 v[32:33], v228 offset:45056
    ds_read_b64_tr_b16 v[34:35], v228 offset:45568
    v_exp_f32 v201, v201
    v_rcp_f32 v185, v185
    v_exp_f32 v202, v202
    v_mfma_f32_32x32x16_bf16 v[120:135], v[36:39], v[12:15], v[120:135]
    ds_read_b64_tr_b16 v[36:37], v228 offset:46080
    ds_read_b64_tr_b16 v[38:39], v228 offset:46592
    v_rcp_f32 v186, v186
    v_exp_f32 v203, v203
    v_rcp_f32 v187, v187
    v_mfma_f32_32x32x16_bf16 v[120:135], v[40:43], v[16:19], v[120:135]
    ds_read_b64_tr_b16 v[40:41], v228 offset:47104
    ds_read_b64_tr_b16 v[42:43], v228 offset:47616
    v_exp_f32 v204, v204
    v_rcp_f32 v188, v188
    v_exp_f32 v205, v205
    v_mfma_f32_32x32x16_bf16 v[120:135], v[44:47], v[20:23], v[120:135]
    ds_read_b64_tr_b16 v[44:45], v228 offset:48128
    ds_read_b64_tr_b16 v[46:47], v228 offset:48640
    v_rcp_f32 v189, v189
    v_exp_f32 v206, v206
    v_rcp_f32 v190, v190
    s_waitcnt lgkmcnt(12)
    v_mfma_f32_32x32x16_bf16 v[72:87], v[48:51], v[216:219], v[72:87]
    ds_read_b64_tr_b16 v[48:49], v229 offset:24576
    ds_read_b64_tr_b16 v[50:51], v229 offset:25088
    v_exp_f32 v207, v207
    v_rcp_f32 v191, v191
    v_exp_f32 v208, v208
    v_mfma_f32_32x32x16_bf16 v[88:103], v[52:55], v[216:219], v[88:103]
    ds_read_b64_tr_b16 v[52:53], v229 offset:25600
    ds_read_b64_tr_b16 v[54:55], v229 offset:26112
    v_rcp_f32 v192, v192
    v_exp_f32 v209, v209
    v_rcp_f32 v193, v193
    v_mfma_f32_32x32x16_bf16 v[104:119], v[56:59], v[216:219], v[104:119]
    ds_read_b64_tr_b16 v[56:57], v229 offset:26624
    ds_read_b64_tr_b16 v[58:59], v229 offset:27136
    v_exp_f32 v210, v210
    v_rcp_f32 v194, v194
    v_exp_f32 v211, v211
    v_mfma_f32_32x32x16_bf16 v[72:87], v[60:63], v[220:223], v[72:87]
    ds_read_b64_tr_b16 v[60:61], v229 offset:27648
    ds_read_b64_tr_b16 v[62:63], v229 offset:28160
    v_rcp_f32 v195, v195
    v_exp_f32 v212, v212
    v_rcp_f32 v196, v196
    v_mfma_f32_32x32x16_bf16 v[88:103], v[64:67], v[220:223], v[88:103]
    ds_read_b64_tr_b16 v[64:65], v229 offset:28672
    ds_read_b64_tr_b16 v[66:67], v229 offset:29184
    v_exp_f32 v213, v213
    v_rcp_f32 v197, v197
    v_exp_f32 v214, v214
    v_mfma_f32_32x32x16_bf16 v[104:119], v[68:71], v[220:223], v[104:119]
    ds_read_b64_tr_b16 v[68:69], v229 offset:29696
    ds_read_b64_tr_b16 v[70:71], v229 offset:30208
    v_rcp_f32 v198, v198
    v_exp_f32 v215, v215
    v_rcp_f32 v199, v199
    v_add_u32 v228, 0x4800, v228
    v_add_u32 v229, 0x4800, v229
    v_pk_mul_f32 v[184:185], v[136:137], v[184:185]
    v_pk_mul_f32 v[186:187], v[138:139], v[186:187]
    v_pk_mul_f32 v[188:189], v[140:141], v[188:189]
    v_pk_mul_f32 v[190:191], v[142:143], v[190:191]
    v_pk_mul_f32 v[192:193], v[144:145], v[192:193]
    v_pk_mul_f32 v[194:195], v[146:147], v[194:195]
    v_pk_mul_f32 v[196:197], v[148:149], v[196:197]
    v_pk_mul_f32 v[198:199], v[150:151], v[198:199]
    v_pk_fma_f32 v[200:201], v[200:201], s[94:95], s[94:95]
    v_pk_fma_f32 v[202:203], v[202:203], s[94:95], s[94:95]
    v_pk_fma_f32 v[204:205], v[204:205], s[94:95], s[94:95]
    v_pk_fma_f32 v[206:207], v[206:207], s[94:95], s[94:95]
    v_pk_fma_f32 v[208:209], v[208:209], s[94:95], s[94:95]
    v_pk_fma_f32 v[210:211], v[210:211], s[94:95], s[94:95]
    v_pk_fma_f32 v[212:213], v[212:213], s[94:95], s[94:95]
    v_pk_fma_f32 v[214:215], v[214:215], s[94:95], s[94:95]
    v_pk_fma_f32 v[168:169], v[120:121], v[120:121], s[92:93] neg_lo:[1,0,0] neg_hi:[1,0,0]
    v_pk_fma_f32 v[170:171], v[122:123], v[122:123], s[92:93] neg_lo:[1,0,0] neg_hi:[1,0,0]
    v_pk_fma_f32 v[172:173], v[124:125], v[124:125], s[92:93] neg_lo:[1,0,0] neg_hi:[1,0,0]
    v_pk_fma_f32 v[174:175], v[126:127], v[126:127], s[92:93] neg_lo:[1,0,0] neg_hi:[1,0,0]
    v_pk_fma_f32 v[176:177], v[128:129], v[128:129], s[92:93] neg_lo:[1,0,0] neg_hi:[1,0,0]
    v_pk_fma_f32 v[178:179], v[130:131], v[130:131], s[92:93] neg_lo:[1,0,0] neg_hi:[1,0,0]
    v_pk_fma_f32 v[180:181], v[132:133], v[132:133], s[92:93] neg_lo:[1,0,0] neg_hi:[1,0,0]
    v_pk_fma_f32 v[182:183], v[134:135], v[134:135], s[92:93] neg_lo:[1,0,0] neg_hi:[1,0,0]
    v_pk_mul_f32 v[168:169], v[120:121], v[168:169]
    v_pk_mul_f32 v[170:171], v[122:123], v[170:171]
    v_pk_mul_f32 v[172:173], v[124:125], v[172:173]
    v_pk_mul_f32 v[174:175], v[126:127], v[174:175]
    v_pk_mul_f32 v[176:177], v[128:129], v[176:177]
    v_pk_mul_f32 v[178:179], v[130:131], v[178:179]
    v_pk_mul_f32 v[180:181], v[132:133], v[180:181]
    v_pk_mul_f32 v[182:183], v[134:135], v[182:183]
    s_add_u32 s58, s58, 1
    s_cmp_lt_u32 s58, 2
    s_cbranch_scc1 L_loop
    s_waitcnt lgkmcnt(12)
    v_mfma_f32_32x32x16_bf16 v[136:151], v[24:27], v[0:3], 0
    ds_read_b64_tr_b16 v[24:25], v228 offset:30720
    ds_read_b64_tr_b16 v[26:27], v228 offset:31232
    v_cvt_pk_bf16_f32 v216, v184, v185
    v_cvt_pk_bf16_f32 v217, v186, v187
    v_cvt_pk_bf16_f32 v218, v188, v189
    v_cvt_pk_bf16_f32 v219, v190, v191
    v_cvt_pk_bf16_f32 v220, v192, v193
    v_cvt_pk_bf16_f32 v221, v194, v195
    v_mfma_f32_32x32x16_bf16 v[136:151], v[28:31], v[4:7], v[136:151]
    ds_read_b64_tr_b16 v[28:29], v228 offset:31744
    ds_read_b64_tr_b16 v[30:31], v228 offset:32256
    v_cvt_pk_bf16_f32 v222, v196, v197
    v_cvt_pk_bf16_f32 v223, v198, v199
    v_exp_f32 v168, v168
    v_rcp_f32 v200, v200
    v_mfma_f32_32x32x16_bf16 v[136:151], v[32:35], v[8:11], v[136:151]
    ds_read_b64_tr_b16 v[32:33], v228 offset:32768
    ds_read_b64_tr_b16 v[34:35], v228 offset:33280
    v_exp_f32 v169, v169
    v_rcp_f32 v201, v201
    v_exp_f32 v170, v170
    v_mfma_f32_32x32x16_bf16 v[136:151], v[36:39], v[12:15], v[136:151]
    ds_read_b64_tr_b16 v[36:37], v228 offset:33792
    ds_read_b64_tr_b16 v[38:39], v228 offset:34304
    v_rcp_f32 v202, v202
    v_exp_f32 v171, v171
    v_rcp_f32 v203, v203
    v_mfma_f32_32x32x16_bf16 v[136:151], v[40:43], v[16:19], v[136:151]
    ds_read_b64_tr_b16 v[40:41], v228 offset:34816
    ds_read_b64_tr_b16 v[42:43], v228 offset:35328
    v_exp_f32 v172, v172
    v_rcp_f32 v204, v204
    v_exp_f32 v173, v173
    v_mfma_f32_32x32x16_bf16 v[136:151], v[44:47], v[20:23], v[136:151]
    ds_read_b64_tr_b16 v[44:45], v228 offset:35840
    ds_read_b64_tr_b16 v[46:47], v228 offset:36352
    v_rcp_f32 v205, v205
    v_exp_f32 v174, v174
    v_rcp_f32 v206, v206
    s_waitcnt lgkmcnt(12)
    v_mfma_f32_32x32x16_bf16 v[72:87], v[48:51], v[216:219], v[72:87]
    ds_read_b64_tr_b16 v[48:49], v229 offset:12288
    ds_read_b64_tr_b16 v[50:51], v229 offset:12800
    v_exp_f32 v175, v175
    v_rcp_f32 v207, v207
    v_exp_f32 v176, v176
    v_mfma_f32_32x32x16_bf16 v[88:103], v[52:55], v[216:219], v[88:103]
    ds_read_b64_tr_b16 v[52:53], v229 offset:13312
    ds_read_b64_tr_b16 v[54:55], v229 offset:13824
    v_rcp_f32 v208, v208
    v_exp_f32 v177, v177
    v_rcp_f32 v209, v209
    v_mfma_f32_32x32x16_bf16 v[104:119], v[56:59], v[216:219], v[104:119]
    ds_read_b64_tr_b16 v[56:57], v229 offset:14336
    ds_read_b64_tr_b16 v[58:59], v229 offset:14848
    v_exp_f32 v178, v178
    v_rcp_f32 v210, v210
    v_exp_f32 v179, v179
    v_mfma_f32_32x32x16_bf16 v[72:87], v[60:63], v[220:223], v[72:87]
    ds_read_b64_tr_b16 v[60:61], v229 offset:15360
    ds_read_b64_tr_b16 v[62:63], v229 offset:15872
    v_rcp_f32 v211, v211
    v_exp_f32 v180, v180
    v_rcp_f32 v212, v212
    v_mfma_f32_32x32x16_bf16 v[88:103], v[64:67], v[220:223], v[88:103]
    ds_read_b64_tr_b16 v[64:65], v229 offset:16384
    ds_read_b64_tr_b16 v[66:67], v229 offset:16896
    v_exp_f32 v181, v181
    v_rcp_f32 v213, v213
    v_exp_f32 v182, v182
    v_mfma_f32_32x32x16_bf16 v[104:119], v[68:71], v[220:223], v[104:119]
    ds_read_b64_tr_b16 v[68:69], v229 offset:17408
    ds_read_b64_tr_b16 v[70:71], v229 offset:17920
    v_rcp_f32 v214, v214
    v_exp_f32 v183, v183
    v_rcp_f32 v215, v215
    v_pk_mul_f32 v[200:201], v[152:153], v[200:201]
    v_pk_mul_f32 v[202:203], v[154:155], v[202:203]
    v_pk_mul_f32 v[204:205], v[156:157], v[204:205]
    v_pk_mul_f32 v[206:207], v[158:159], v[206:207]
    v_pk_mul_f32 v[208:209], v[160:161], v[208:209]
    v_pk_mul_f32 v[210:211], v[162:163], v[210:211]
    v_pk_mul_f32 v[212:213], v[164:165], v[212:213]
    v_pk_mul_f32 v[214:215], v[166:167], v[214:215]
    v_pk_fma_f32 v[168:169], v[168:169], s[94:95], s[94:95]
    v_pk_fma_f32 v[170:171], v[170:171], s[94:95], s[94:95]
    v_pk_fma_f32 v[172:173], v[172:173], s[94:95], s[94:95]
    v_pk_fma_f32 v[174:175], v[174:175], s[94:95], s[94:95]
    v_pk_fma_f32 v[176:177], v[176:177], s[94:95], s[94:95]
    v_pk_fma_f32 v[178:179], v[178:179], s[94:95], s[94:95]
    v_pk_fma_f32 v[180:181], v[180:181], s[94:95], s[94:95]
    v_pk_fma_f32 v[182:183], v[182:183], s[94:95], s[94:95]
    v_pk_fma_f32 v[184:185], v[136:137], v[136:137], s[92:93] neg_lo:[1,0,0] neg_hi:[1,0,0]
    v_pk_fma_f32 v[186:187], v[138:139], v[138:139], s[92:93] neg_lo:[1,0,0] neg_hi:[1,0,0]
    v_pk_fma_f32 v[188:189], v[140:141], v[140:141], s[92:93] neg_lo:[1,0,0] neg_hi:[1,0,0]
    v_pk_fma_f32 v[190:191], v[142:143], v[142:143], s[92:93] neg_lo:[1,0,0] neg_hi:[1,0,0]
    v_pk_fma_f32 v[192:193], v[144:145], v[144:145], s[92:93] neg_lo:[1,0,0] neg_hi:[1,0,0]
    v_pk_fma_f32 v[194:195], v[146:147], v[146:147], s[92:93] neg_lo:[1,0,0] neg_hi:[1,0,0]
    v_pk_fma_f32 v[196:197], v[148:149], v[148:149], s[92:93] neg_lo:[1,0,0] neg_hi:[1,0,0]
    v_pk_fma_f32 v[198:199], v[150:151], v[150:151], s[92:93] neg_lo:[1,0,0] neg_hi:[1,0,0]
    v_pk_mul_f32 v[184:185], v[136:137], v[184:185]
    v_pk_mul_f32 v[186:187], v[138:139], v[186:187]
    v_pk_mul_f32 v[188:189], v[140:141], v[188:189]
    v_pk_mul_f32 v[190:191], v[142:143], v[190:191]
    v_pk_mul_f32 v[192:193], v[144:145], v[192:193]
    v_pk_mul_f32 v[194:195], v[146:147], v[194:195]
    v_pk_mul_f32 v[196:197], v[148:149], v[196:197]
    v_pk_mul_f32 v[198:199], v[150:151], v[198:199]
    s_waitcnt lgkmcnt(12)
    v_mfma_f32_32x32x16_bf16 v[152:167], v[24:27], v[0:3], 0
    v_cvt_pk_bf16_f32 v216, v200, v201
    v_cvt_pk_bf16_f32 v217, v202, v203
    v_cvt_pk_bf16_f32 v218, v204, v205
    v_cvt_pk_bf16_f32 v219, v206, v207
    v_cvt_pk_bf16_f32 v220, v208, v209
    v_cvt_pk_bf16_f32 v221, v210, v211
    v_mfma_f32_32x32x16_bf16 v[152:167], v[28:31], v[4:7], v[152:167]
    v_cvt_pk_bf16_f32 v222, v212, v213
    v_cvt_pk_bf16_f32 v223, v214, v215
    v_exp_f32 v184, v184
    v_rcp_f32 v168, v168
    v_mfma_f32_32x32x16_bf16 v[152:167], v[32:35], v[8:11], v[152:167]
    v_exp_f32 v185, v185
    v_rcp_f32 v169, v169
    v_exp_f32 v186, v186
    v_mfma_f32_32x32x16_bf16 v[152:167], v[36:39], v[12:15], v[152:167]
    v_rcp_f32 v170, v170
    v_exp_f32 v187, v187
    v_rcp_f32 v171, v171
    v_mfma_f32_32x32x16_bf16 v[152:167], v[40:43], v[16:19], v[152:167]
    v_exp_f32 v188, v188
    v_rcp_f32 v172, v172
    v_exp_f32 v189, v189
    v_mfma_f32_32x32x16_bf16 v[152:167], v[44:47], v[20:23], v[152:167]
    v_rcp_f32 v173, v173
    v_exp_f32 v190, v190
    v_rcp_f32 v174, v174
    s_waitcnt lgkmcnt(0)
    v_mfma_f32_32x32x16_bf16 v[72:87], v[48:51], v[216:219], v[72:87]
    ds_read_b64_tr_b16 v[48:49], v229 offset:18432
    ds_read_b64_tr_b16 v[50:51], v229 offset:18944
    ds_read_b128 v[24:27], v225 offset:0
    ds_read_b128 v[28:31], v225 offset:1024
    ds_read_b128 v[32:35], v225 offset:2048
    v_exp_f32 v191, v191
    v_rcp_f32 v175, v175
    v_exp_f32 v192, v192
    v_mfma_f32_32x32x16_bf16 v[88:103], v[52:55], v[216:219], v[88:103]
    ds_read_b64_tr_b16 v[52:53], v229 offset:19456
    ds_read_b64_tr_b16 v[54:55], v229 offset:19968
    v_rcp_f32 v176, v176
    v_exp_f32 v193, v193
    v_rcp_f32 v177, v177
    v_mfma_f32_32x32x16_bf16 v[104:119], v[56:59], v[216:219], v[104:119]
    ds_read_b64_tr_b16 v[56:57], v229 offset:20480
    ds_read_b64_tr_b16 v[58:59], v229 offset:20992
    v_exp_f32 v194, v194
    v_rcp_f32 v178, v178
    v_exp_f32 v195, v195
    v_mfma_f32_32x32x16_bf16 v[72:87], v[60:63], v[220:223], v[72:87]
    ds_read_b64_tr_b16 v[60:61], v229 offset:21504
    ds_read_b64_tr_b16 v[62:63], v229 offset:22016
    v_rcp_f32 v179, v179
    v_exp_f32 v196, v196
    v_rcp_f32 v180, v180
    v_mfma_f32_32x32x16_bf16 v[88:103], v[64:67], v[220:223], v[88:103]
    ds_read_b64_tr_b16 v[64:65], v229 offset:22528
    ds_read_b64_tr_b16 v[66:67], v229 offset:23040
    v_exp_f32 v197, v197
    v_rcp_f32 v181, v181
    v_exp_f32 v198, v198
    v_mfma_f32_32x32x16_bf16 v[104:119], v[68:71], v[220:223], v[104:119]
    ds_read_b64_tr_b16 v[68:69], v229 offset:23552
    ds_read_b64_tr_b16 v[70:71], v229 offset:24064
    v_rcp_f32 v182, v182
    v_exp_f32 v199, v199
    v_rcp_f32 v183, v183
    v_pk_mul_f32 v[168:169], v[120:121], v[168:169]
    v_pk_mul_f32 v[170:171], v[122:123], v[170:171]
    v_pk_mul_f32 v[172:173], v[124:125], v[172:173]
    v_pk_mul_f32 v[174:175], v[126:127], v[174:175]
    v_pk_mul_f32 v[176:177], v[128:129], v[176:177]
    v_pk_mul_f32 v[178:179], v[130:131], v[178:179]
    v_pk_mul_f32 v[180:181], v[132:133], v[180:181]
    v_pk_mul_f32 v[182:183], v[134:135], v[182:183]
    v_pk_fma_f32 v[184:185], v[184:185], s[94:95], s[94:95]
    v_pk_fma_f32 v[186:187], v[186:187], s[94:95], s[94:95]
    v_pk_fma_f32 v[188:189], v[188:189], s[94:95], s[94:95]
    v_pk_fma_f32 v[190:191], v[190:191], s[94:95], s[94:95]
    v_pk_fma_f32 v[192:193], v[192:193], s[94:95], s[94:95]
    v_pk_fma_f32 v[194:195], v[194:195], s[94:95], s[94:95]
    v_pk_fma_f32 v[196:197], v[196:197], s[94:95], s[94:95]
    v_pk_fma_f32 v[198:199], v[198:199], s[94:95], s[94:95]
    v_pk_fma_f32 v[200:201], v[152:153], v[152:153], s[92:93] neg_lo:[1,0,0] neg_hi:[1,0,0]
    v_pk_fma_f32 v[202:203], v[154:155], v[154:155], s[92:93] neg_lo:[1,0,0] neg_hi:[1,0,0]
    v_pk_fma_f32 v[204:205], v[156:157], v[156:157], s[92:93] neg_lo:[1,0,0] neg_hi:[1,0,0]
    v_pk_fma_f32 v[206:207], v[158:159], v[158:159], s[92:93] neg_lo:[1,0,0] neg_hi:[1,0,0]
    v_pk_fma_f32 v[208:209], v[160:161], v[160:161], s[92:93] neg_lo:[1,0,0] neg_hi:[1,0,0]
    v_pk_fma_f32 v[210:211], v[162:163], v[162:163], s[92:93] neg_lo:[1,0,0] neg_hi:[1,0,0]
    v_pk_fma_f32 v[212:213], v[164:165], v[164:165], s[92:93] neg_lo:[1,0,0] neg_hi:[1,0,0]
    v_pk_fma_f32 v[214:215], v[166:167], v[166:167], s[92:93] neg_lo:[1,0,0] neg_hi:[1,0,0]
    v_pk_mul_f32 v[200:201], v[152:153], v[200:201]
    v_pk_mul_f32 v[202:203], v[154:155], v[202:203]
    v_pk_mul_f32 v[204:205], v[156:157], v[204:205]
    v_pk_mul_f32 v[206:207], v[158:159], v[206:207]
    v_pk_mul_f32 v[208:209], v[160:161], v[208:209]
    v_pk_mul_f32 v[210:211], v[162:163], v[210:211]
    v_pk_mul_f32 v[212:213], v[164:165], v[212:213]
    v_pk_mul_f32 v[214:215], v[166:167], v[214:215]
    s_waitcnt vmcnt(0)
    s_waitcnt lgkmcnt(10)
    v_mfma_f32_32x32x16_bf16 v[72:87], v[24:27], v[232:235], v[72:87]
    v_cvt_pk_bf16_f32 v216, v168, v169
    v_cvt_pk_bf16_f32 v217, v170, v171
    v_cvt_pk_bf16_f32 v218, v172, v173
    v_cvt_pk_bf16_f32 v219, v174, v175
    v_cvt_pk_bf16_f32 v220, v176, v177
    v_cvt_pk_bf16_f32 v221, v178, v179
    v_mfma_f32_32x32x16_bf16 v[72:87], v[28:31], v[236:239], v[72:87]
    v_cvt_pk_bf16_f32 v222, v180, v181
    v_cvt_pk_bf16_f32 v223, v182, v183
    v_exp_f32 v200, v200
    v_rcp_f32 v184, v184
    v_mfma_f32_32x32x16_bf16 v[88:103], v[24:27], v[240:243], v[88:103]
    v_exp_f32 v201, v201
    v_rcp_f32 v185, v185
    v_exp_f32 v202, v202
    v_mfma_f32_32x32x16_bf16 v[88:103], v[28:31], v[244:247], v[88:103]
    v_rcp_f32 v186, v186
    v_exp_f32 v203, v203
    v_rcp_f32 v187, v187
    v_mfma_f32_32x32x16_bf16 v[104:119], v[24:27], v[248:251], v[104:119]
    v_exp_f32 v204, v204
    v_rcp_f32 v188, v188
    v_exp_f32 v205, v205
    v_mfma_f32_32x32x16_bf16 v[104:119], v[28:31], v[252:255], v[104:119]
    v_rcp_f32 v189, v189
    v_exp_f32 v206, v206
    v_rcp_f32 v190, v190
    s_waitcnt lgkmcnt(0)
    v_mfma_f32_32x32x16_bf16 v[72:87], v[48:51], v[216:219], v[72:87]
    ds_read_b64_tr_b16 v[48:49], v229 offset:24576
    ds_read_b64_tr_b16 v[50:51], v229 offset:25088
    v_exp_f32 v207, v207
    v_rcp_f32 v191, v191
    v_exp_f32 v208, v208
    v_mfma_f32_32x32x16_bf16 v[88:103], v[52:55], v[216:219], v[88:103]
    ds_read_b64_tr_b16 v[52:53], v229 offset:25600
    ds_read_b64_tr_b16 v[54:55], v229 offset:26112
    v_rcp_f32 v192, v192
    v_exp_f32 v209, v209
    v_rcp_f32 v193, v193
    v_mfma_f32_32x32x16_bf16 v[104:119], v[56:59], v[216:219], v[104:119]
    ds_read_b64_tr_b16 v[56:57], v229 offset:26624
    ds_read_b64_tr_b16 v[58:59], v229 offset:27136
    v_exp_f32 v210, v210
    v_rcp_f32 v194, v194
    v_exp_f32 v211, v211
    v_mfma_f32_32x32x16_bf16 v[72:87], v[60:63], v[220:223], v[72:87]
    ds_read_b64_tr_b16 v[60:61], v229 offset:27648
    ds_read_b64_tr_b16 v[62:63], v229 offset:28160
    v_rcp_f32 v195, v195
    v_exp_f32 v212, v212
    v_rcp_f32 v196, v196
    v_mfma_f32_32x32x16_bf16 v[88:103], v[64:67], v[220:223], v[88:103]
    ds_read_b64_tr_b16 v[64:65], v229 offset:28672
    ds_read_b64_tr_b16 v[66:67], v229 offset:29184
    v_exp_f32 v213, v213
    v_rcp_f32 v197, v197
    v_exp_f32 v214, v214
    v_mfma_f32_32x32x16_bf16 v[104:119], v[68:71], v[220:223], v[104:119]
    ds_read_b64_tr_b16 v[68:69], v229 offset:29696
    ds_read_b64_tr_b16 v[70:71], v229 offset:30208
    v_rcp_f32 v198, v198
    v_exp_f32 v215, v215
    v_rcp_f32 v199, v199
    v_add_u32 v32, s75, v32
    v_add_u32 v33, s75, v33
    v_pk_mul_f32 v[184:185], v[136:137], v[184:185]
    v_pk_mul_f32 v[186:187], v[138:139], v[186:187]
    v_pk_mul_f32 v[188:189], v[140:141], v[188:189]
    v_pk_mul_f32 v[190:191], v[142:143], v[190:191]
    v_pk_mul_f32 v[192:193], v[144:145], v[192:193]
    v_pk_mul_f32 v[194:195], v[146:147], v[194:195]
    v_pk_mul_f32 v[196:197], v[148:149], v[196:197]
    v_pk_mul_f32 v[198:199], v[150:151], v[198:199]
    v_pk_fma_f32 v[200:201], v[200:201], s[94:95], s[94:95]
    v_pk_fma_f32 v[202:203], v[202:203], s[94:95], s[94:95]
    v_pk_fma_f32 v[204:205], v[204:205], s[94:95], s[94:95]
    v_pk_fma_f32 v[206:207], v[206:207], s[94:95], s[94:95]
    v_pk_fma_f32 v[208:209], v[208:209], s[94:95], s[94:95]
    v_pk_fma_f32 v[210:211], v[210:211], s[94:95], s[94:95]
    v_pk_fma_f32 v[212:213], v[212:213], s[94:95], s[94:95]
    v_pk_fma_f32 v[214:215], v[214:215], s[94:95], s[94:95]
    s_waitcnt lgkmcnt(0)
    v_cvt_pk_bf16_f32 v216, v184, v185
    v_cvt_pk_bf16_f32 v217, v186, v187
    v_cvt_pk_bf16_f32 v218, v188, v189
    v_cvt_pk_bf16_f32 v219, v190, v191
    v_cvt_pk_bf16_f32 v220, v192, v193
    v_cvt_pk_bf16_f32 v221, v194, v195
    v_cvt_pk_bf16_f32 v222, v196, v197
    v_cvt_pk_bf16_f32 v223, v198, v199
    v_mfma_f32_32x32x16_bf16 v[72:87], v[48:51], v[216:219], v[72:87]
    ds_read_b64_tr_b16 v[48:49], v229 offset:30720
    ds_read_b64_tr_b16 v[50:51], v229 offset:31232
    v_rcp_f32 v200, v200
    v_rcp_f32 v201, v201
    v_rcp_f32 v202, v202
    v_mfma_f32_32x32x16_bf16 v[88:103], v[52:55], v[216:219], v[88:103]
    ds_read_b64_tr_b16 v[52:53], v229 offset:31744
    ds_read_b64_tr_b16 v[54:55], v229 offset:32256
    v_rcp_f32 v203, v203
    v_rcp_f32 v204, v204
    v_rcp_f32 v205, v205
    v_mfma_f32_32x32x16_bf16 v[104:119], v[56:59], v[216:219], v[104:119]
    ds_read_b64_tr_b16 v[56:57], v229 offset:32768
    ds_read_b64_tr_b16 v[58:59], v229 offset:33280
    v_rcp_f32 v206, v206
    v_rcp_f32 v207, v207
    v_rcp_f32 v208, v208
    v_mfma_f32_32x32x16_bf16 v[72:87], v[60:63], v[220:223], v[72:87]
    ds_read_b64_tr_b16 v[60:61], v229 offset:33792
    ds_read_b64_tr_b16 v[62:63], v229 offset:34304
    v_rcp_f32 v209, v209
    v_rcp_f32 v210, v210
    v_rcp_f32 v211, v211
    v_mfma_f32_32x32x16_bf16 v[88:103], v[64:67], v[220:223], v[88:103]
    ds_read_b64_tr_b16 v[64:65], v229 offset:34816
    ds_read_b64_tr_b16 v[66:67], v229 offset:35328
    v_rcp_f32 v212, v212
    v_rcp_f32 v213, v213
    v_rcp_f32 v214, v214
    v_mfma_f32_32x32x16_bf16 v[104:119], v[68:71], v[220:223], v[104:119]
    ds_read_b64_tr_b16 v[68:69], v229 offset:35840
    ds_read_b64_tr_b16 v[70:71], v229 offset:36352
    v_rcp_f32 v215, v215
    v_pk_mul_f32 v[200:201], v[152:153], v[200:201]
    v_pk_mul_f32 v[202:203], v[154:155], v[202:203]
    v_pk_mul_f32 v[204:205], v[156:157], v[204:205]
    v_pk_mul_f32 v[206:207], v[158:159], v[206:207]
    v_pk_mul_f32 v[208:209], v[160:161], v[208:209]
    v_pk_mul_f32 v[210:211], v[162:163], v[210:211]
    v_pk_mul_f32 v[212:213], v[164:165], v[212:213]
    v_pk_mul_f32 v[214:215], v[166:167], v[214:215]
    s_waitcnt lgkmcnt(0)
    v_cvt_pk_bf16_f32 v216, v200, v201
    v_cvt_pk_bf16_f32 v217, v202, v203
    v_cvt_pk_bf16_f32 v218, v204, v205
    v_cvt_pk_bf16_f32 v219, v206, v207
    v_cvt_pk_bf16_f32 v220, v208, v209
    v_cvt_pk_bf16_f32 v221, v210, v211
    v_cvt_pk_bf16_f32 v222, v212, v213
    v_cvt_pk_bf16_f32 v223, v214, v215
    v_mfma_f32_32x32x16_bf16 v[72:87], v[48:51], v[216:219], v[72:87]
    s_nop 0
    v_mfma_f32_32x32x16_bf16 v[72:87], v[60:63], v[220:223], v[72:87]
    v_mfma_f32_32x32x16_bf16 v[88:103], v[52:55], v[216:219], v[88:103]
    v_mfma_f32_32x32x16_bf16 v[88:103], v[64:67], v[220:223], v[88:103]
    s_nop 9
    v_cvt_pk_bf16_f32 v120, v72, v73
    v_cvt_pk_bf16_f32 v121, v74, v75
    v_cvt_pk_bf16_f32 v122, v76, v77
    v_cvt_pk_bf16_f32 v123, v78, v79
    v_cvt_pk_bf16_f32 v124, v80, v81
    v_cvt_pk_bf16_f32 v125, v82, v83
    v_cvt_pk_bf16_f32 v126, v84, v85
    v_cvt_pk_bf16_f32 v127, v86, v87
    ds_write_b128 v32, v[120:123] offset:0
    ds_write_b128 v32, v[124:127] offset:16
    v_mfma_f32_32x32x16_bf16 v[104:119], v[56:59], v[216:219], v[104:119]
    v_mfma_f32_32x32x16_bf16 v[104:119], v[68:71], v[220:223], v[104:119]
    v_cvt_pk_bf16_f32 v128, v88, v89
    v_cvt_pk_bf16_f32 v129, v90, v91
    v_cvt_pk_bf16_f32 v130, v92, v93
    v_cvt_pk_bf16_f32 v131, v94, v95
    v_cvt_pk_bf16_f32 v132, v96, v97
    v_cvt_pk_bf16_f32 v133, v98, v99
    v_cvt_pk_bf16_f32 v134, v100, v101
    v_cvt_pk_bf16_f32 v135, v102, v103
    ds_write_b128 v32, v[128:131] offset:32
    ds_write_b128 v32, v[132:135] offset:48
    s_nop 1
    v_cvt_pk_bf16_f32 v136, v104, v105
    v_cvt_pk_bf16_f32 v137, v106, v107
    v_cvt_pk_bf16_f32 v138, v108, v109
    v_cvt_pk_bf16_f32 v139, v110, v111
    v_cvt_pk_bf16_f32 v140, v112, v113
    v_cvt_pk_bf16_f32 v141, v114, v115
    v_cvt_pk_bf16_f32 v142, v116, v117
    v_cvt_pk_bf16_f32 v143, v118, v119
    ds_write_b128 v32, v[136:139] offset:64
    ds_write_b128 v32, v[140:143] offset:80
    s_waitcnt lgkmcnt(0)
    s_mov_b32 exec_hi, 0xfffffff
    ds_read_b128 v[168:171], v33 offset:0
    ds_read_b128 v[172:175], v33 offset:1040
    ds_read_b128 v[176:179], v33 offset:2944
    ds_read_b128 v[180:183], v33 offset:3984
    ds_read_b128 v[184:187], v33 offset:2080
    ds_read_b128 v[188:191], v33 offset:5024
    ds_read_b128 v[192:195], v33 offset:5888
    s_waitcnt lgkmcnt(6)
    buffer_store_dwordx4 v[168:171], v35, s[32:35], s72 offen offset:0 sc1 nt
    s_waitcnt lgkmcnt(5)
    buffer_store_dwordx4 v[172:175], v35, s[32:35], s72 offen offset:960 sc1 nt
    s_waitcnt lgkmcnt(4)
    buffer_store_dwordx4 v[176:179], v35, s[32:35], s73 offen offset:0 sc1 nt
    s_waitcnt lgkmcnt(3)
    buffer_store_dwordx4 v[180:183], v35, s[32:35], s73 offen offset:960 sc1 nt
    s_waitcnt lgkmcnt(2)
    s_mov_b32 exec_hi, 0xffff
    buffer_store_dwordx4 v[184:187], v35, s[32:35], s72 offen offset:1920 sc1 nt
    s_waitcnt lgkmcnt(1)
    buffer_store_dwordx4 v[188:191], v35, s[32:35], s73 offen offset:1920 sc1 nt
    s_waitcnt lgkmcnt(0)
    buffer_store_dwordx4 v[192:195], v34, s[32:35], s74 offen sc1 nt
    s_endpgm
L_end:
s_endpgm
L_cend:
.section .rodata,"a"
.p2align 6
.amdhsa_kernel standalone__convnext_block__vision_kernel
  .amdhsa_next_free_vgpr 256
  .amdhsa_next_free_sgpr 102
  .amdhsa_accum_offset 256
  .amdhsa_group_segment_fixed_size 0
  .amdhsa_kernarg_size 56
  .amdhsa_user_sgpr_count 2
  .amdhsa_user_sgpr_kernarg_segment_ptr 1
  .amdhsa_system_sgpr_workgroup_id_x 1
.end_amdhsa_kernel
```
